```python
import torch

def _softmax(x, axis=-1):
    return torch.softmax(x, dim=axis)
def _gelu(x):
    return torch.nn.functional.gelu(x, approximate="tanh")
def _silu(x):
    return torch.nn.functional.silu(x)
def _sigmoid(x):
    return torch.sigmoid(x)
def _layernorm(x, axis=-1, eps=1e-5):
    m = x.mean(dim=axis, keepdim=True)
    v = x.var(dim=axis, keepdim=True, unbiased=False)
    return (x - m) / torch.sqrt(v + eps)
def _scatter_add(tgt, idx, src, axis=0):
    return tgt.clone().index_add_(axis, idx, src)
def _segment_sum(src, seg, n):
    out = torch.zeros((n,) + src.shape[1:], dtype=src.dtype)
    return out.index_add_(0, seg, src)
def _pad(x, pw):
    flat = tuple(v for pair in reversed(pw) for v in pair)
    return torch.nn.functional.pad(x, flat)

kernel_name = 'standalone__paged_block_table_kv_radixattention__sampling'

def setup_inputs():

    _w = (lambda a: (lambda t: t.to(torch.bfloat16) if t.is_floating_point() else t)(torch.as_tensor(a)))
    B, H, Hkv, Dh = 8, 32, 8, 128
    Lk = 4096
    bs = 16
    nb = max(2, Lk // bs)
    P = max(1, nb // 2)
    n_phys = P + B * (nb - P)
    shared = torch.arange(P, dtype=torch.int64)
    priv = P + torch.arange(B * (nb - P), dtype=torch.int64).reshape(B, nb - P)
    bt = torch.cat([torch.tile(shared[None, :], (B, 1)), priv], dim=1)
    ctx = nb * bs - (torch.arange(1, B + 1, dtype=torch.int64) * 2654435761) % max(1, (nb * bs - P * bs) // 2)
    return {
        "q": _w((lambda *s: torch.randn(*s, dtype=torch.bfloat16) * 0.8)(B, H, Dh)),
        "k_cache": _w((lambda *s: torch.randn(*s, dtype=torch.bfloat16) * 0.8)(n_phys, bs, Hkv, Dh)),
        "v_cache": _w((lambda *s: torch.randn(*s, dtype=torch.bfloat16) * 0.05)(n_phys, bs, Hkv, Dh)),
        "block_table": _w(bt.to(torch.int64)),
        "ctx_lens": _w(torch.as_tensor(ctx).to(torch.int64)),
    }

def reference(q, k_cache, v_cache, block_table, ctx_lens):
    B, H, Dh = q.shape
    n_phys, bs, Hkv, _ = k_cache.shape
    nb = block_table.shape[1]
    Lk = nb * bs
    rep = H // Hkv
    k = k_cache[block_table].reshape(B, Lk, Hkv, Dh)
    v = v_cache[block_table].reshape(B, Lk, Hkv, Dh)
    k = (lambda x, n, axis: torch.repeat_interleave(x, n, dim=axis))(k, rep, axis=2)
    v = (lambda x, n, axis: torch.repeat_interleave(x, n, dim=axis))(v, rep, axis=2)
    scores = torch.einsum("bhd,bkhd->bhk", q, k) * (Dh ** -0.5)
    pos = torch.arange(Lk)
    valid = pos[None, :] < ctx_lens[:, None]
    scores = torch.where(valid[:, None, :], scores, -1e9)
    p = _softmax(scores, axis=-1)
    return torch.einsum("bhk,bkhd->bhd", p, v)
```

```asm
; @launch grid=(256,1,1) block=(320,1,1) lds=163840
.amdgcn_target "amdgcn-amd-amdhsa--gfx950"
.text
.globl standalone__paged_block_table_kv_radixattention__sampling_kernel
.p2align 8
.type standalone__paged_block_table_kv_radixattention__sampling_kernel,@function
standalone__paged_block_table_kv_radixattention__sampling_kernel:
    s_cmp_ge_u32 s2, 256
    s_cbranch_scc1 L_end
    s_load_dwordx16 s[4:19], s[0:1], 0
    v_and_b32 v1, 63, v0
    v_lshrrev_b32 v2, 6, v0
    s_and_b32 s57, s2, 7
    s_lshl_b32 s57, s57, 2
    s_lshr_b32 s57, 0x76432501, s57
    s_and_b32 s57, s57, 7
    s_lshr_b32 s58, s2, 3
    v_readfirstlane_b32 s59, v2
    s_mov_b32 s60, 128
    s_mov_b32 s40, 128
    s_mov_b32 s41, 229
    s_mov_b32 s42, 303
    s_mov_b32 s43, 414
    s_mov_b32 s44, 498
    s_mov_b32 s45, 619
    s_mov_b32 s46, 713
    s_mov_b32 s47, 780
    s_mov_b32 s48, 884
    s_mov_b32 s50, 155
    s_mov_b32 s51, 337
    s_mov_b32 s52, 482
    s_mov_b32 s53, 654
    s_mov_b32 s54, 789
    s_mov_b32 s55, 951
    s_mov_b32 s56, 1140
    s_mov_b32 s61, 7
    s_mov_b32 s62, 1
    s_mov_b32 s63, 0
    v_mov_b32 v222, 0
    s_cmp_lg_u32 s59, 4
    s_cbranch_scc1 C_entry
LD_entry:
    v_lshrrev_b32 v192, 4, v1
    v_and_b32 v193, 15, v1
    s_lshl_b32 s96, s57, 8
    v_lshl_or_b32 v194, v192, 2, 0
    v_xor_b32 v194, v194, v193
    v_lshlrev_b32 v194, 4, v194
    v_lshl_add_u32 v194, v192, 11, v194
    v_add_u32 v194, 0, v194
    v_add_u32 v2, s96, v194
    v_lshl_or_b32 v194, v192, 2, 1
    v_xor_b32 v194, v194, v193
    v_lshlrev_b32 v194, 4, v194
    v_lshl_add_u32 v194, v192, 11, v194
    v_add_u32 v194, 7168, v194
    v_add_u32 v3, s96, v194
    v_lshl_or_b32 v194, v192, 2, 2
    v_xor_b32 v194, v194, v193
    v_lshlrev_b32 v194, 4, v194
    v_lshl_add_u32 v194, v192, 11, v194
    v_add_u32 v194, 14336, v194
    v_add_u32 v4, s96, v194
    v_lshl_or_b32 v194, v192, 2, 3
    v_xor_b32 v194, v194, v193
    v_lshlrev_b32 v194, 4, v194
    v_lshl_add_u32 v194, v192, 11, v194
    v_add_u32 v194, 21504, v194
    v_add_u32 v5, s96, v194
    s_lshl_b32 s96, s63, 5
    s_add_u32 s101, s58, s96
    s_lshl_b32 s96, s101, 2
    v_lshrrev_b32 v192, 3, v1
    v_add_u32 v192, s96, v192
    v_mul_u32_u24 v192, s48, v192
    v_add_u32 v193, s48, v192
    v_lshrrev_b32 v192, s61, v192
    v_lshrrev_b32 v193, s61, v193
    v_and_b32 v194, 7, v1
    v_add_u32 v213, v192, v194
    v_mov_b32 v214, 0
    v_cmpx_le_u32 vcc, s41, v213
    v_mov_b32 v214, s50
    v_cmpx_le_u32 vcc, s42, v213
    v_mov_b32 v214, s51
    v_cmpx_le_u32 vcc, s43, v213
    v_mov_b32 v214, s52
    v_cmpx_le_u32 vcc, s44, v213
    v_mov_b32 v214, s53
    v_cmpx_le_u32 vcc, s45, v213
    v_mov_b32 v214, s54
    v_cmpx_le_u32 vcc, s46, v213
    v_mov_b32 v214, s55
    v_cmpx_le_u32 vcc, s47, v213
    v_mov_b32 v214, s56
    s_mov_b64 exec, -1
    v_add_u32 v215, v213, v214
    v_cmp_gt_u32 vcc, v193, v213
    v_lshrrev_b32 v192, 8, v215
    v_and_b32 v218, 0xff, v215
    v_lshl_add_u32 v218, v192, 7, v218
    v_mov_b32 v193, 0x480
    v_min_u32 v218, 0x480, v218
    v_cndmask_b32 v218, v193, v218, vcc
    v_lshlrev_b32 v218, 15, v218
    v_lshrrev_b32 v192, 4, v1
    v_and_b32 v193, 15, v1
    v_lshl_or_b32 v194, v192, 2, 0
    v_xor_b32 v194, v194, v193
    v_lshlrev_b32 v194, 4, v194
    v_lshl_add_u32 v32, v192, 8, v194
    v_lshl_or_b32 v194, v192, 2, 1
    v_xor_b32 v194, v194, v193
    v_lshlrev_b32 v194, 4, v194
    v_lshl_add_u32 v33, v192, 8, v194
    v_lshl_or_b32 v194, v192, 2, 2
    v_xor_b32 v194, v194, v193
    v_lshlrev_b32 v194, 4, v194
    v_lshl_add_u32 v34, v192, 8, v194
    v_lshl_or_b32 v194, v192, 2, 3
    v_xor_b32 v194, v194, v193
    v_lshlrev_b32 v194, 4, v194
    v_lshl_add_u32 v35, v192, 8, v194
    s_waitcnt lgkmcnt(0)
    s_mov_b32 s28, s4
    s_and_b32 s29, s5, 0xffff
    s_mov_b32 s30, 0x10000
    s_mov_b32 s31, 0x20000
    s_lshl_b32 s96, s57, 10
    s_mov_b32 m0, 131072
    s_add_u32 s97, s96, 0
    buffer_load_dwordx4 v32, s[28:31], s97 offen lds
    s_mov_b32 m0, 132096
    s_add_u32 s97, s96, 8192
    buffer_load_dwordx4 v33, s[28:31], s97 offen lds
    s_mov_b32 m0, 133120
    s_add_u32 s97, s96, 16384
    buffer_load_dwordx4 v34, s[28:31], s97 offen lds
    s_mov_b32 m0, 134144
    s_add_u32 s97, s96, 24576
    buffer_load_dwordx4 v35, s[28:31], s97 offen lds
    s_mov_b32 m0, 135168
    s_add_u32 s97, s96, 32768
    buffer_load_dwordx4 v32, s[28:31], s97 offen lds
    s_mov_b32 m0, 136192
    s_add_u32 s97, s96, 40960
    buffer_load_dwordx4 v33, s[28:31], s97 offen lds
    s_mov_b32 m0, 137216
    s_add_u32 s97, s96, 49152
    buffer_load_dwordx4 v34, s[28:31], s97 offen lds
    s_mov_b32 m0, 138240
    s_add_u32 s97, s96, 57344
    buffer_load_dwordx4 v35, s[28:31], s97 offen lds
    s_mov_b32 s20, s6
    s_and_b32 s21, s7, 0xffff
    s_mov_b32 s22, 0x2400000
    s_mov_b32 s23, 0x20000
    s_mov_b32 s24, s8
    s_and_b32 s25, s9, 0xffff
    s_mov_b32 s26, 0x2400000
    s_mov_b32 s27, 0x20000
    s_mov_b32 s28, s18
    s_and_b32 s29, s19, 0xffff
    s_mov_b32 s30, 0x1200000
    s_mov_b32 s31, 0x20000
LD_issue:
    v_readlane_b32 s64, v218, 0
    v_readlane_b32 s65, v218, 1
    v_readlane_b32 s66, v218, 8
    v_readlane_b32 s67, v218, 9
    v_readlane_b32 s68, v218, 16
    v_readlane_b32 s69, v218, 17
    v_readlane_b32 s70, v218, 24
    v_readlane_b32 s71, v218, 25
    s_mov_b32 m0, 0
    s_nop 0
    buffer_load_dwordx4 v2, s[20:23], s64 offen offset:0 nt lds
    buffer_load_dwordx4 v3, s[20:23], s64 offen offset:1024 nt lds
    buffer_load_dwordx4 v4, s[20:23], s64 offen offset:2048 nt lds
    buffer_load_dwordx4 v5, s[20:23], s64 offen offset:3072 nt lds
    s_mov_b32 m0, 4096
    s_nop 0
    buffer_load_dwordx4 v2, s[20:23], s65 offen offset:0 nt lds
    buffer_load_dwordx4 v3, s[20:23], s65 offen offset:1024 nt lds
    buffer_load_dwordx4 v4, s[20:23], s65 offen offset:2048 nt lds
    buffer_load_dwordx4 v5, s[20:23], s65 offen offset:3072 nt lds
    s_mov_b32 m0, 32768
    s_nop 0
    buffer_load_dwordx4 v2, s[20:23], s66 offen offset:0 nt lds
    buffer_load_dwordx4 v3, s[20:23], s66 offen offset:1024 nt lds
    buffer_load_dwordx4 v4, s[20:23], s66 offen offset:2048 nt lds
    buffer_load_dwordx4 v5, s[20:23], s66 offen offset:3072 nt lds
    s_mov_b32 m0, 36864
    s_nop 0
    buffer_load_dwordx4 v2, s[20:23], s67 offen offset:0 nt lds
    buffer_load_dwordx4 v3, s[20:23], s67 offen offset:1024 nt lds
    buffer_load_dwordx4 v4, s[20:23], s67 offen offset:2048 nt lds
    buffer_load_dwordx4 v5, s[20:23], s67 offen offset:3072 nt lds
    s_mov_b32 m0, 65536
    s_nop 0
    buffer_load_dwordx4 v2, s[20:23], s68 offen offset:0 nt lds
    buffer_load_dwordx4 v3, s[20:23], s68 offen offset:1024 nt lds
    buffer_load_dwordx4 v4, s[20:23], s68 offen offset:2048 nt lds
    buffer_load_dwordx4 v5, s[20:23], s68 offen offset:3072 nt lds
    s_mov_b32 m0, 69632
    s_nop 0
    buffer_load_dwordx4 v2, s[20:23], s69 offen offset:0 nt lds
    buffer_load_dwordx4 v3, s[20:23], s69 offen offset:1024 nt lds
    buffer_load_dwordx4 v4, s[20:23], s69 offen offset:2048 nt lds
    buffer_load_dwordx4 v5, s[20:23], s69 offen offset:3072 nt lds
    s_mov_b32 m0, 98304
    s_nop 0
    buffer_load_dwordx4 v2, s[20:23], s70 offen offset:0 nt lds
    buffer_load_dwordx4 v3, s[20:23], s70 offen offset:1024 nt lds
    buffer_load_dwordx4 v4, s[20:23], s70 offen offset:2048 nt lds
    buffer_load_dwordx4 v5, s[20:23], s70 offen offset:3072 nt lds
    s_mov_b32 m0, 102400
    s_nop 0
    buffer_load_dwordx4 v2, s[20:23], s71 offen offset:0 nt lds
    buffer_load_dwordx4 v3, s[20:23], s71 offen offset:1024 nt lds
    buffer_load_dwordx4 v4, s[20:23], s71 offen offset:2048 nt lds
    buffer_load_dwordx4 v5, s[20:23], s71 offen offset:3072 nt lds
    v_readlane_b32 s72, v218, 2
    v_readlane_b32 s73, v218, 3
    v_readlane_b32 s74, v218, 10
    v_readlane_b32 s75, v218, 11
    v_readlane_b32 s76, v218, 18
    v_readlane_b32 s77, v218, 19
    v_readlane_b32 s78, v218, 26
    v_readlane_b32 s79, v218, 27
    s_mov_b32 m0, 8192
    s_nop 0
    buffer_load_dwordx4 v2, s[20:23], s72 offen offset:0 nt lds
    buffer_load_dwordx4 v3, s[20:23], s72 offen offset:1024 nt lds
    buffer_load_dwordx4 v4, s[20:23], s72 offen offset:2048 nt lds
    buffer_load_dwordx4 v5, s[20:23], s72 offen offset:3072 nt lds
    s_mov_b32 m0, 12288
    s_nop 0
    buffer_load_dwordx4 v2, s[20:23], s73 offen offset:0 nt lds
    buffer_load_dwordx4 v3, s[20:23], s73 offen offset:1024 nt lds
    buffer_load_dwordx4 v4, s[20:23], s73 offen offset:2048 nt lds
    buffer_load_dwordx4 v5, s[20:23], s73 offen offset:3072 nt lds
    s_mov_b32 m0, 40960
    s_nop 0
    buffer_load_dwordx4 v2, s[20:23], s74 offen offset:0 nt lds
    buffer_load_dwordx4 v3, s[20:23], s74 offen offset:1024 nt lds
    buffer_load_dwordx4 v4, s[20:23], s74 offen offset:2048 nt lds
    buffer_load_dwordx4 v5, s[20:23], s74 offen offset:3072 nt lds
    s_mov_b32 m0, 45056
    s_nop 0
    buffer_load_dwordx4 v2, s[20:23], s75 offen offset:0 nt lds
    buffer_load_dwordx4 v3, s[20:23], s75 offen offset:1024 nt lds
    buffer_load_dwordx4 v4, s[20:23], s75 offen offset:2048 nt lds
    buffer_load_dwordx4 v5, s[20:23], s75 offen offset:3072 nt lds
    s_mov_b32 m0, 73728
    s_nop 0
    buffer_load_dwordx4 v2, s[20:23], s76 offen offset:0 nt lds
    buffer_load_dwordx4 v3, s[20:23], s76 offen offset:1024 nt lds
    buffer_load_dwordx4 v4, s[20:23], s76 offen offset:2048 nt lds
    buffer_load_dwordx4 v5, s[20:23], s76 offen offset:3072 nt lds
    s_mov_b32 m0, 77824
    s_nop 0
    buffer_load_dwordx4 v2, s[20:23], s77 offen offset:0 nt lds
    buffer_load_dwordx4 v3, s[20:23], s77 offen offset:1024 nt lds
    buffer_load_dwordx4 v4, s[20:23], s77 offen offset:2048 nt lds
    buffer_load_dwordx4 v5, s[20:23], s77 offen offset:3072 nt lds
    s_mov_b32 m0, 106496
    s_nop 0
    buffer_load_dwordx4 v2, s[20:23], s78 offen offset:0 nt lds
    buffer_load_dwordx4 v3, s[20:23], s78 offen offset:1024 nt lds
    buffer_load_dwordx4 v4, s[20:23], s78 offen offset:2048 nt lds
    buffer_load_dwordx4 v5, s[20:23], s78 offen offset:3072 nt lds
    s_mov_b32 m0, 110592
    s_nop 0
    buffer_load_dwordx4 v2, s[20:23], s79 offen offset:0 nt lds
    buffer_load_dwordx4 v3, s[20:23], s79 offen offset:1024 nt lds
    buffer_load_dwordx4 v4, s[20:23], s79 offen offset:2048 nt lds
    buffer_load_dwordx4 v5, s[20:23], s79 offen offset:3072 nt lds
    v_readlane_b32 s64, v218, 4
    v_readlane_b32 s65, v218, 5
    v_readlane_b32 s66, v218, 12
    v_readlane_b32 s67, v218, 13
    v_readlane_b32 s68, v218, 20
    v_readlane_b32 s69, v218, 21
    v_readlane_b32 s70, v218, 28
    v_readlane_b32 s71, v218, 29
    s_mov_b32 m0, 16384
    s_nop 0
    buffer_load_dwordx4 v2, s[20:23], s64 offen offset:0 nt lds
    buffer_load_dwordx4 v3, s[20:23], s64 offen offset:1024 nt lds
    buffer_load_dwordx4 v4, s[20:23], s64 offen offset:2048 nt lds
    buffer_load_dwordx4 v5, s[20:23], s64 offen offset:3072 nt lds
    s_mov_b32 m0, 20480
    s_nop 0
    buffer_load_dwordx4 v2, s[20:23], s65 offen offset:0 nt lds
    buffer_load_dwordx4 v3, s[20:23], s65 offen offset:1024 nt lds
    buffer_load_dwordx4 v4, s[20:23], s65 offen offset:2048 nt lds
    buffer_load_dwordx4 v5, s[20:23], s65 offen offset:3072 nt lds
    s_mov_b32 m0, 49152
    s_nop 0
    buffer_load_dwordx4 v2, s[20:23], s66 offen offset:0 nt lds
    buffer_load_dwordx4 v3, s[20:23], s66 offen offset:1024 nt lds
    buffer_load_dwordx4 v4, s[20:23], s66 offen offset:2048 nt lds
    buffer_load_dwordx4 v5, s[20:23], s66 offen offset:3072 nt lds
    s_mov_b32 m0, 53248
    s_nop 0
    buffer_load_dwordx4 v2, s[20:23], s67 offen offset:0 nt lds
    buffer_load_dwordx4 v3, s[20:23], s67 offen offset:1024 nt lds
    buffer_load_dwordx4 v4, s[20:23], s67 offen offset:2048 nt lds
    buffer_load_dwordx4 v5, s[20:23], s67 offen offset:3072 nt lds
    s_mov_b32 m0, 81920
    s_nop 0
    buffer_load_dwordx4 v2, s[20:23], s68 offen offset:0 nt lds
    buffer_load_dwordx4 v3, s[20:23], s68 offen offset:1024 nt lds
    buffer_load_dwordx4 v4, s[20:23], s68 offen offset:2048 nt lds
    buffer_load_dwordx4 v5, s[20:23], s68 offen offset:3072 nt lds
    s_mov_b32 m0, 86016
    s_nop 0
    buffer_load_dwordx4 v2, s[20:23], s69 offen offset:0 nt lds
    buffer_load_dwordx4 v3, s[20:23], s69 offen offset:1024 nt lds
    buffer_load_dwordx4 v4, s[20:23], s69 offen offset:2048 nt lds
    buffer_load_dwordx4 v5, s[20:23], s69 offen offset:3072 nt lds
    s_mov_b32 m0, 114688
    s_nop 0
    buffer_load_dwordx4 v2, s[20:23], s70 offen offset:0 nt lds
    buffer_load_dwordx4 v3, s[20:23], s70 offen offset:1024 nt lds
    buffer_load_dwordx4 v4, s[20:23], s70 offen offset:2048 nt lds
    buffer_load_dwordx4 v5, s[20:23], s70 offen offset:3072 nt lds
    s_mov_b32 m0, 118784
    s_nop 0
    buffer_load_dwordx4 v2, s[20:23], s71 offen offset:0 nt lds
    buffer_load_dwordx4 v3, s[20:23], s71 offen offset:1024 nt lds
    buffer_load_dwordx4 v4, s[20:23], s71 offen offset:2048 nt lds
    buffer_load_dwordx4 v5, s[20:23], s71 offen offset:3072 nt lds
    s_waitcnt vmcnt(62)
    s_barrier
    v_readlane_b32 s72, v218, 6
    v_readlane_b32 s73, v218, 7
    v_readlane_b32 s74, v218, 14
    v_readlane_b32 s75, v218, 15
    v_readlane_b32 s76, v218, 22
    v_readlane_b32 s77, v218, 23
    v_readlane_b32 s78, v218, 30
    v_readlane_b32 s79, v218, 31
    s_mov_b32 m0, 24576
    s_nop 0
    buffer_load_dwordx4 v2, s[20:23], s72 offen offset:0 nt lds
    buffer_load_dwordx4 v3, s[20:23], s72 offen offset:1024 nt lds
    buffer_load_dwordx4 v4, s[20:23], s72 offen offset:2048 nt lds
    buffer_load_dwordx4 v5, s[20:23], s72 offen offset:3072 nt lds
    s_mov_b32 m0, 28672
    s_nop 0
    buffer_load_dwordx4 v2, s[20:23], s73 offen offset:0 nt lds
    buffer_load_dwordx4 v3, s[20:23], s73 offen offset:1024 nt lds
    buffer_load_dwordx4 v4, s[20:23], s73 offen offset:2048 nt lds
    buffer_load_dwordx4 v5, s[20:23], s73 offen offset:3072 nt lds
    s_mov_b32 m0, 57344
    s_nop 0
    buffer_load_dwordx4 v2, s[20:23], s74 offen offset:0 nt lds
    buffer_load_dwordx4 v3, s[20:23], s74 offen offset:1024 nt lds
    buffer_load_dwordx4 v4, s[20:23], s74 offen offset:2048 nt lds
    buffer_load_dwordx4 v5, s[20:23], s74 offen offset:3072 nt lds
    s_mov_b32 m0, 61440
    s_nop 0
    buffer_load_dwordx4 v2, s[20:23], s75 offen offset:0 nt lds
    buffer_load_dwordx4 v3, s[20:23], s75 offen offset:1024 nt lds
    buffer_load_dwordx4 v4, s[20:23], s75 offen offset:2048 nt lds
    buffer_load_dwordx4 v5, s[20:23], s75 offen offset:3072 nt lds
    s_mov_b32 m0, 90112
    s_nop 0
    buffer_load_dwordx4 v2, s[20:23], s76 offen offset:0 nt lds
    buffer_load_dwordx4 v3, s[20:23], s76 offen offset:1024 nt lds
    buffer_load_dwordx4 v4, s[20:23], s76 offen offset:2048 nt lds
    buffer_load_dwordx4 v5, s[20:23], s76 offen offset:3072 nt lds
    s_mov_b32 m0, 94208
    s_nop 0
    buffer_load_dwordx4 v2, s[20:23], s77 offen offset:0 nt lds
    buffer_load_dwordx4 v3, s[20:23], s77 offen offset:1024 nt lds
    buffer_load_dwordx4 v4, s[20:23], s77 offen offset:2048 nt lds
    buffer_load_dwordx4 v5, s[20:23], s77 offen offset:3072 nt lds
    s_mov_b32 m0, 122880
    s_nop 0
    buffer_load_dwordx4 v2, s[20:23], s78 offen offset:0 nt lds
    buffer_load_dwordx4 v3, s[20:23], s78 offen offset:1024 nt lds
    buffer_load_dwordx4 v4, s[20:23], s78 offen offset:2048 nt lds
    buffer_load_dwordx4 v5, s[20:23], s78 offen offset:3072 nt lds
    s_mov_b32 m0, 126976
    s_nop 0
    buffer_load_dwordx4 v2, s[20:23], s79 offen offset:0 nt lds
    buffer_load_dwordx4 v3, s[20:23], s79 offen offset:1024 nt lds
    buffer_load_dwordx4 v4, s[20:23], s79 offen offset:2048 nt lds
    buffer_load_dwordx4 v5, s[20:23], s79 offen offset:3072 nt lds
    s_waitcnt vmcnt(62)
    s_barrier
    v_readlane_b32 s64, v218, 0
    v_readlane_b32 s65, v218, 1
    v_readlane_b32 s66, v218, 8
    v_readlane_b32 s67, v218, 9
    v_readlane_b32 s68, v218, 16
    v_readlane_b32 s69, v218, 17
    v_readlane_b32 s70, v218, 24
    v_readlane_b32 s71, v218, 25
    s_mov_b32 m0, 0
    s_nop 0
    buffer_load_dwordx4 v2, s[24:27], s64 offen offset:0 nt lds
    buffer_load_dwordx4 v3, s[24:27], s64 offen offset:1024 nt lds
    buffer_load_dwordx4 v4, s[24:27], s64 offen offset:2048 nt lds
    buffer_load_dwordx4 v5, s[24:27], s64 offen offset:3072 nt lds
    s_mov_b32 m0, 4096
    s_nop 0
    buffer_load_dwordx4 v2, s[24:27], s65 offen offset:0 nt lds
    buffer_load_dwordx4 v3, s[24:27], s65 offen offset:1024 nt lds
    buffer_load_dwordx4 v4, s[24:27], s65 offen offset:2048 nt lds
    buffer_load_dwordx4 v5, s[24:27], s65 offen offset:3072 nt lds
    s_mov_b32 m0, 32768
    s_nop 0
    buffer_load_dwordx4 v2, s[24:27], s66 offen offset:0 nt lds
    buffer_load_dwordx4 v3, s[24:27], s66 offen offset:1024 nt lds
    buffer_load_dwordx4 v4, s[24:27], s66 offen offset:2048 nt lds
    buffer_load_dwordx4 v5, s[24:27], s66 offen offset:3072 nt lds
    s_mov_b32 m0, 36864
    s_nop 0
    buffer_load_dwordx4 v2, s[24:27], s67 offen offset:0 nt lds
    buffer_load_dwordx4 v3, s[24:27], s67 offen offset:1024 nt lds
    buffer_load_dwordx4 v4, s[24:27], s67 offen offset:2048 nt lds
    buffer_load_dwordx4 v5, s[24:27], s67 offen offset:3072 nt lds
    s_mov_b32 m0, 65536
    s_nop 0
    buffer_load_dwordx4 v2, s[24:27], s68 offen offset:0 nt lds
    buffer_load_dwordx4 v3, s[24:27], s68 offen offset:1024 nt lds
    buffer_load_dwordx4 v4, s[24:27], s68 offen offset:2048 nt lds
    buffer_load_dwordx4 v5, s[24:27], s68 offen offset:3072 nt lds
    s_mov_b32 m0, 69632
    s_nop 0
    buffer_load_dwordx4 v2, s[24:27], s69 offen offset:0 nt lds
    buffer_load_dwordx4 v3, s[24:27], s69 offen offset:1024 nt lds
    buffer_load_dwordx4 v4, s[24:27], s69 offen offset:2048 nt lds
    buffer_load_dwordx4 v5, s[24:27], s69 offen offset:3072 nt lds
    s_mov_b32 m0, 98304
    s_nop 0
    buffer_load_dwordx4 v2, s[24:27], s70 offen offset:0 nt lds
    buffer_load_dwordx4 v3, s[24:27], s70 offen offset:1024 nt lds
    buffer_load_dwordx4 v4, s[24:27], s70 offen offset:2048 nt lds
    buffer_load_dwordx4 v5, s[24:27], s70 offen offset:3072 nt lds
    s_mov_b32 m0, 102400
    s_nop 0
    buffer_load_dwordx4 v2, s[24:27], s71 offen offset:0 nt lds
    buffer_load_dwordx4 v3, s[24:27], s71 offen offset:1024 nt lds
    buffer_load_dwordx4 v4, s[24:27], s71 offen offset:2048 nt lds
    buffer_load_dwordx4 v5, s[24:27], s71 offen offset:3072 nt lds
    s_waitcnt vmcnt(62)
    s_barrier
    v_readlane_b32 s72, v218, 2
    v_readlane_b32 s73, v218, 3
    v_readlane_b32 s74, v218, 10
    v_readlane_b32 s75, v218, 11
    v_readlane_b32 s76, v218, 18
    v_readlane_b32 s77, v218, 19
    v_readlane_b32 s78, v218, 26
    v_readlane_b32 s79, v218, 27
    s_mov_b32 m0, 8192
    s_nop 0
    buffer_load_dwordx4 v2, s[24:27], s72 offen offset:0 nt lds
    buffer_load_dwordx4 v3, s[24:27], s72 offen offset:1024 nt lds
    buffer_load_dwordx4 v4, s[24:27], s72 offen offset:2048 nt lds
    buffer_load_dwordx4 v5, s[24:27], s72 offen offset:3072 nt lds
    s_mov_b32 m0, 12288
    s_nop 0
    buffer_load_dwordx4 v2, s[24:27], s73 offen offset:0 nt lds
    buffer_load_dwordx4 v3, s[24:27], s73 offen offset:1024 nt lds
    buffer_load_dwordx4 v4, s[24:27], s73 offen offset:2048 nt lds
    buffer_load_dwordx4 v5, s[24:27], s73 offen offset:3072 nt lds
    s_mov_b32 m0, 40960
    s_nop 0
    buffer_load_dwordx4 v2, s[24:27], s74 offen offset:0 nt lds
    buffer_load_dwordx4 v3, s[24:27], s74 offen offset:1024 nt lds
    buffer_load_dwordx4 v4, s[24:27], s74 offen offset:2048 nt lds
    buffer_load_dwordx4 v5, s[24:27], s74 offen offset:3072 nt lds
    s_mov_b32 m0, 45056
    s_nop 0
    buffer_load_dwordx4 v2, s[24:27], s75 offen offset:0 nt lds
    buffer_load_dwordx4 v3, s[24:27], s75 offen offset:1024 nt lds
    buffer_load_dwordx4 v4, s[24:27], s75 offen offset:2048 nt lds
    buffer_load_dwordx4 v5, s[24:27], s75 offen offset:3072 nt lds
    s_mov_b32 m0, 73728
    s_nop 0
    buffer_load_dwordx4 v2, s[24:27], s76 offen offset:0 nt lds
    buffer_load_dwordx4 v3, s[24:27], s76 offen offset:1024 nt lds
    buffer_load_dwordx4 v4, s[24:27], s76 offen offset:2048 nt lds
    buffer_load_dwordx4 v5, s[24:27], s76 offen offset:3072 nt lds
    s_mov_b32 m0, 77824
    s_nop 0
    buffer_load_dwordx4 v2, s[24:27], s77 offen offset:0 nt lds
    buffer_load_dwordx4 v3, s[24:27], s77 offen offset:1024 nt lds
    buffer_load_dwordx4 v4, s[24:27], s77 offen offset:2048 nt lds
    buffer_load_dwordx4 v5, s[24:27], s77 offen offset:3072 nt lds
    s_mov_b32 m0, 106496
    s_nop 0
    buffer_load_dwordx4 v2, s[24:27], s78 offen offset:0 nt lds
    buffer_load_dwordx4 v3, s[24:27], s78 offen offset:1024 nt lds
    buffer_load_dwordx4 v4, s[24:27], s78 offen offset:2048 nt lds
    buffer_load_dwordx4 v5, s[24:27], s78 offen offset:3072 nt lds
    s_mov_b32 m0, 110592
    s_nop 0
    buffer_load_dwordx4 v2, s[24:27], s79 offen offset:0 nt lds
    buffer_load_dwordx4 v3, s[24:27], s79 offen offset:1024 nt lds
    buffer_load_dwordx4 v4, s[24:27], s79 offen offset:2048 nt lds
    buffer_load_dwordx4 v5, s[24:27], s79 offen offset:3072 nt lds
    s_waitcnt vmcnt(62)
    s_barrier
    v_readlane_b32 s64, v218, 4
    v_readlane_b32 s65, v218, 5
    v_readlane_b32 s66, v218, 12
    v_readlane_b32 s67, v218, 13
    s_nop 1
    s_mov_b32 m0, 16384
    s_nop 0
    buffer_load_dwordx4 v2, s[24:27], s64 offen offset:0 nt lds
    buffer_load_dwordx4 v3, s[24:27], s64 offen offset:1024 nt lds
    buffer_load_dwordx4 v4, s[24:27], s64 offen offset:2048 nt lds
    buffer_load_dwordx4 v5, s[24:27], s64 offen offset:3072 nt lds
    s_mov_b32 m0, 20480
    s_nop 0
    buffer_load_dwordx4 v2, s[24:27], s65 offen offset:0 nt lds
    buffer_load_dwordx4 v3, s[24:27], s65 offen offset:1024 nt lds
    buffer_load_dwordx4 v4, s[24:27], s65 offen offset:2048 nt lds
    buffer_load_dwordx4 v5, s[24:27], s65 offen offset:3072 nt lds
    s_mov_b32 m0, 49152
    s_nop 0
    buffer_load_dwordx4 v2, s[24:27], s66 offen offset:0 nt lds
    buffer_load_dwordx4 v3, s[24:27], s66 offen offset:1024 nt lds
    buffer_load_dwordx4 v4, s[24:27], s66 offen offset:2048 nt lds
    buffer_load_dwordx4 v5, s[24:27], s66 offen offset:3072 nt lds
    s_mov_b32 m0, 53248
    s_nop 0
    buffer_load_dwordx4 v2, s[24:27], s67 offen offset:0 nt lds
    buffer_load_dwordx4 v3, s[24:27], s67 offen offset:1024 nt lds
    buffer_load_dwordx4 v4, s[24:27], s67 offen offset:2048 nt lds
    buffer_load_dwordx4 v5, s[24:27], s67 offen offset:3072 nt lds
    s_barrier
    v_mov_b32 v192, 24576
    v_mov_b32 v193, 90112
    ds_read_b32 v194, v192
    ds_read_b32 v195, v192 offset:32768
    ds_read_b32 v196, v193
    ds_read_b32 v197, v193 offset:32768
    ds_read_b64 v[220:221], v192 offset:8
    s_waitcnt lgkmcnt(0)
    v_readfirstlane_b32 s6, v220
    v_readfirstlane_b32 s7, v221
    v_or3_b32 v194, v194, v195, v196
    v_or_b32 v194, v194, v197
    s_nop 0
    v_readfirstlane_b32 s96, v194
    s_nop 1
    s_cmp_lg_u32 s96, 0
    s_cbranch_scc1 LD_fallback
    v_readlane_b32 s68, v218, 20
    v_readlane_b32 s69, v218, 21
    v_readlane_b32 s70, v218, 28
    v_readlane_b32 s71, v218, 29
    s_nop 1
    s_mov_b32 m0, 81920
    s_nop 0
    buffer_load_dwordx4 v2, s[24:27], s68 offen offset:0 nt lds
    buffer_load_dwordx4 v3, s[24:27], s68 offen offset:1024 nt lds
    buffer_load_dwordx4 v4, s[24:27], s68 offen offset:2048 nt lds
    buffer_load_dwordx4 v5, s[24:27], s68 offen offset:3072 nt lds
    s_mov_b32 m0, 86016
    s_nop 0
    buffer_load_dwordx4 v2, s[24:27], s69 offen offset:0 nt lds
    buffer_load_dwordx4 v3, s[24:27], s69 offen offset:1024 nt lds
    buffer_load_dwordx4 v4, s[24:27], s69 offen offset:2048 nt lds
    buffer_load_dwordx4 v5, s[24:27], s69 offen offset:3072 nt lds
    s_mov_b32 m0, 114688
    s_nop 0
    buffer_load_dwordx4 v2, s[24:27], s70 offen offset:0 nt lds
    buffer_load_dwordx4 v3, s[24:27], s70 offen offset:1024 nt lds
    buffer_load_dwordx4 v4, s[24:27], s70 offen offset:2048 nt lds
    buffer_load_dwordx4 v5, s[24:27], s70 offen offset:3072 nt lds
    s_mov_b32 m0, 118784
    s_nop 0
    buffer_load_dwordx4 v2, s[24:27], s71 offen offset:0 nt lds
    buffer_load_dwordx4 v3, s[24:27], s71 offen offset:1024 nt lds
    buffer_load_dwordx4 v4, s[24:27], s71 offen offset:2048 nt lds
    buffer_load_dwordx4 v5, s[24:27], s71 offen offset:3072 nt lds
    v_readlane_b32 s72, v218, 6
    v_readlane_b32 s73, v218, 7
    v_readlane_b32 s74, v218, 14
    v_readlane_b32 s75, v218, 15
    v_readlane_b32 s76, v218, 22
    v_readlane_b32 s77, v218, 23
    v_readlane_b32 s78, v218, 30
    v_readlane_b32 s79, v218, 31
    s_mov_b32 m0, 24576
    s_nop 0
    buffer_load_dwordx4 v2, s[24:27], s72 offen offset:0 nt lds
    buffer_load_dwordx4 v3, s[24:27], s72 offen offset:1024 nt lds
    buffer_load_dwordx4 v4, s[24:27], s72 offen offset:2048 nt lds
    buffer_load_dwordx4 v5, s[24:27], s72 offen offset:3072 nt lds
    s_mov_b32 m0, 28672
    s_nop 0
    buffer_load_dwordx4 v2, s[24:27], s73 offen offset:0 nt lds
    buffer_load_dwordx4 v3, s[24:27], s73 offen offset:1024 nt lds
    buffer_load_dwordx4 v4, s[24:27], s73 offen offset:2048 nt lds
    buffer_load_dwordx4 v5, s[24:27], s73 offen offset:3072 nt lds
    s_mov_b32 m0, 57344
    s_nop 0
    buffer_load_dwordx4 v2, s[24:27], s74 offen offset:0 nt lds
    buffer_load_dwordx4 v3, s[24:27], s74 offen offset:1024 nt lds
    buffer_load_dwordx4 v4, s[24:27], s74 offen offset:2048 nt lds
    buffer_load_dwordx4 v5, s[24:27], s74 offen offset:3072 nt lds
    s_mov_b32 m0, 61440
    s_nop 0
    buffer_load_dwordx4 v2, s[24:27], s75 offen offset:0 nt lds
    buffer_load_dwordx4 v3, s[24:27], s75 offen offset:1024 nt lds
    buffer_load_dwordx4 v4, s[24:27], s75 offen offset:2048 nt lds
    buffer_load_dwordx4 v5, s[24:27], s75 offen offset:3072 nt lds
    s_mov_b32 m0, 90112
    s_nop 0
    buffer_load_dwordx4 v2, s[24:27], s76 offen offset:0 nt lds
    buffer_load_dwordx4 v3, s[24:27], s76 offen offset:1024 nt lds
    buffer_load_dwordx4 v4, s[24:27], s76 offen offset:2048 nt lds
    buffer_load_dwordx4 v5, s[24:27], s76 offen offset:3072 nt lds
    s_mov_b32 m0, 94208
    s_nop 0
    buffer_load_dwordx4 v2, s[24:27], s77 offen offset:0 nt lds
    buffer_load_dwordx4 v3, s[24:27], s77 offen offset:1024 nt lds
    buffer_load_dwordx4 v4, s[24:27], s77 offen offset:2048 nt lds
    buffer_load_dwordx4 v5, s[24:27], s77 offen offset:3072 nt lds
    s_mov_b32 m0, 122880
    s_nop 0
    buffer_load_dwordx4 v2, s[24:27], s78 offen offset:0 nt lds
    buffer_load_dwordx4 v3, s[24:27], s78 offen offset:1024 nt lds
    buffer_load_dwordx4 v4, s[24:27], s78 offen offset:2048 nt lds
    buffer_load_dwordx4 v5, s[24:27], s78 offen offset:3072 nt lds
    s_mov_b32 m0, 126976
    s_nop 0
    buffer_load_dwordx4 v2, s[24:27], s79 offen offset:0 nt lds
    buffer_load_dwordx4 v3, s[24:27], s79 offen offset:1024 nt lds
    buffer_load_dwordx4 v4, s[24:27], s79 offen offset:2048 nt lds
    buffer_load_dwordx4 v5, s[24:27], s79 offen offset:3072 nt lds
    s_waitcnt vmcnt(62)
    s_barrier
    s_lshr_b32 s64, s58, 2
    s_and_b32 s65, s58, 3
    s_mov_b32 s70, s40
    s_mov_b32 s71, s41
    s_cmp_eq_u32 s64, 1
    s_cselect_b32 s70, s41, s70
    s_cselect_b32 s71, s42, s71
    s_cmp_eq_u32 s64, 2
    s_cselect_b32 s70, s42, s70
    s_cselect_b32 s71, s43, s71
    s_cmp_eq_u32 s64, 3
    s_cselect_b32 s70, s43, s70
    s_cselect_b32 s71, s44, s71
    s_cmp_eq_u32 s64, 4
    s_cselect_b32 s70, s44, s70
    s_cselect_b32 s71, s45, s71
    s_cmp_eq_u32 s64, 5
    s_cselect_b32 s70, s45, s70
    s_cselect_b32 s71, s46, s71
    s_cmp_eq_u32 s64, 6
    s_cselect_b32 s70, s46, s70
    s_cselect_b32 s71, s47, s71
    s_cmp_eq_u32 s64, 7
    s_cselect_b32 s70, s47, s70
    s_cselect_b32 s71, s48, s71
    v_lshlrev_b32 v6, 2, v1
    v_mul_lo_u32 v6, v6, s48
    v_lshrrev_b32 v6, s61, v6
    s_sub_u32 s96, s61, 2
    s_lshl_b32 s96, 1, s96
    v_cmp_gt_u32 s[76:77], s96, v1
    v_cmp_gt_u32 vcc, s60, v6
    s_and_b64 vcc, vcc, s[76:77]
    s_bcnt1_i32_b64 s66, vcc
    v_cmp_ge_u32 vcc, s70, v6
    s_and_b64 vcc, vcc, s[76:77]
    s_bcnt1_i32_b64 s67, vcc
    s_sub_u32 s67, s67, 1
    s_max_u32 s67, s67, s66
    v_cmp_gt_u32 vcc, s71, v6
    s_and_b64 vcc, vcc, s[76:77]
    s_bcnt1_i32_b64 s97, vcc
    s_sub_i32 s97, s97, s67
    s_max_i32 s97, s97, 0
    s_cmp_gt_u32 s71, s70
    s_cselect_b32 s97, s97, 0
    s_add_u32 s68, s66, s97
    s_sub_u32 s67, s67, s66
    s_lshl_b32 s72, s57, 6
    v_and_b32 v34, 31, v1
    v_lshrrev_b32 v35, 5, v1
    s_mov_b32 s78, 0
    s_mov_b32 s79, -1
    v_lshlrev_b32 v39, 4, v34
    s_lshl_b32 s96, s65, 9
    s_lshl_b32 s97, s64, 11
    s_add_u32 s96, s96, s97
    s_add_u32 s96, s96, 0x100000
    v_add_u32 v39, s96, v39
    v_lshlrev_b32 v36, 2, v1
    v_lshlrev_b32 v37, 4, v35
    v_lshrrev_b32 v38, 2, v1
    v_mov_b32 v10, 0xf149f2ca
    v_mov_b32 v14, 0
    v_mov_b32 v18, 0
    v_mov_b32 v19, 0
    v_mov_b32 v20, 0
    v_mov_b32 v21, 0
    s_mov_b32 s69, 0
    s_mov_b32 s93, 0x04000c0c
    s_mov_b32 s94, 0x0706000c
    s_lshl_b32 s92, s64, 13
    s_lshl_b32 s97, s57, 10
    s_add_u32 s92, s92, s97
    s_lshl_b32 s97, s65, 6
    s_add_u32 s92, s92, s97
    s_sub_u32 s74, s68, s69
    s_add_u32 s96, s69, 0
    s_cmp_gt_u32 s74, 0
    s_cselect_b32 s96, s96, s69
    s_add_u32 s97, s96, s67
    s_cmp_lt_u32 s96, s66
    s_cselect_b32 s96, s96, s97
    s_add_u32 s96, s96, s72
    s_lshl_b32 s80, s96, 14
    s_add_u32 s96, s69, 1
    s_cmp_gt_u32 s74, 1
    s_cselect_b32 s96, s96, s69
    s_add_u32 s97, s96, s67
    s_cmp_lt_u32 s96, s66
    s_cselect_b32 s96, s96, s97
    s_add_u32 s96, s96, s72
    s_lshl_b32 s81, s96, 14
    s_add_u32 s96, s69, 2
    s_cmp_gt_u32 s74, 2
    s_cselect_b32 s96, s96, s69
    s_add_u32 s97, s96, s67
    s_cmp_lt_u32 s96, s66
    s_cselect_b32 s96, s96, s97
    s_add_u32 s96, s96, s72
    s_lshl_b32 s82, s96, 14
    s_add_u32 s96, s69, 3
    s_cmp_gt_u32 s74, 3
    s_cselect_b32 s96, s96, s69
    s_add_u32 s97, s96, s67
    s_cmp_lt_u32 s96, s66
    s_cselect_b32 s96, s96, s97
    s_add_u32 s96, s96, s72
    s_lshl_b32 s83, s96, 14
    s_add_u32 s96, s69, 4
    s_cmp_gt_u32 s74, 4
    s_cselect_b32 s96, s96, s69
    s_add_u32 s97, s96, s67
    s_cmp_lt_u32 s96, s66
    s_cselect_b32 s96, s96, s97
    s_add_u32 s96, s96, s72
    s_lshl_b32 s84, s96, 14
    s_add_u32 s96, s69, 5
    s_cmp_gt_u32 s74, 5
    s_cselect_b32 s96, s96, s69
    s_add_u32 s97, s96, s67
    s_cmp_lt_u32 s96, s66
    s_cselect_b32 s96, s96, s97
    s_add_u32 s96, s96, s72
    s_lshl_b32 s85, s96, 14
    s_add_u32 s96, s69, 6
    s_cmp_gt_u32 s74, 6
    s_cselect_b32 s96, s96, s69
    s_add_u32 s97, s96, s67
    s_cmp_lt_u32 s96, s66
    s_cselect_b32 s96, s96, s97
    s_add_u32 s96, s96, s72
    s_lshl_b32 s86, s96, 14
    s_add_u32 s96, s69, 7
    s_cmp_gt_u32 s74, 7
    s_cselect_b32 s96, s96, s69
    s_add_u32 s97, s96, s67
    s_cmp_lt_u32 s96, s66
    s_cselect_b32 s96, s96, s97
    s_add_u32 s96, s96, s72
    s_lshl_b32 s87, s96, 14
    s_add_u32 s96, s69, 8
    s_cmp_gt_u32 s74, 8
    s_cselect_b32 s96, s96, s69
    s_add_u32 s97, s96, s67
    s_cmp_lt_u32 s96, s66
    s_cselect_b32 s96, s96, s97
    s_add_u32 s96, s96, s72
    s_lshl_b32 s88, s96, 14
    s_add_u32 s96, s69, 9
    s_cmp_gt_u32 s74, 9
    s_cselect_b32 s96, s96, s69
    s_add_u32 s97, s96, s67
    s_cmp_lt_u32 s96, s66
    s_cselect_b32 s96, s96, s97
    s_add_u32 s96, s96, s72
    s_lshl_b32 s89, s96, 14
    s_add_u32 s96, s69, 10
    s_cmp_gt_u32 s74, 10
    s_cselect_b32 s96, s96, s69
    s_add_u32 s97, s96, s67
    s_cmp_lt_u32 s96, s66
    s_cselect_b32 s96, s96, s97
    s_add_u32 s96, s96, s72
    s_lshl_b32 s90, s96, 14
    s_add_u32 s96, s69, 11
    s_cmp_gt_u32 s74, 11
    s_cselect_b32 s96, s96, s69
    s_add_u32 s97, s96, s67
    s_cmp_lt_u32 s96, s66
    s_cselect_b32 s96, s96, s97
    s_add_u32 s96, s96, s72
    s_lshl_b32 s91, s96, 14
    v_mov_b32 v48, s80
    v_mov_b32 v49, s81
    v_cndmask_b32 v48, v48, v49, s[78:79]
    v_add_u32 v40, v48, v39
    v_mov_b32 v48, s82
    v_mov_b32 v49, s83
    v_cndmask_b32 v48, v48, v49, s[78:79]
    v_add_u32 v41, v48, v39
    v_mov_b32 v48, s84
    v_mov_b32 v49, s85
    v_cndmask_b32 v48, v48, v49, s[78:79]
    v_add_u32 v42, v48, v39
    v_mov_b32 v48, s86
    v_mov_b32 v49, s87
    v_cndmask_b32 v48, v48, v49, s[78:79]
    v_add_u32 v43, v48, v39
    v_mov_b32 v48, s88
    v_mov_b32 v49, s89
    v_cndmask_b32 v48, v48, v49, s[78:79]
    v_add_u32 v44, v48, v39
    v_mov_b32 v48, s90
    v_mov_b32 v49, s91
    v_cndmask_b32 v48, v48, v49, s[78:79]
    v_add_u32 v45, v48, v39
    v_add_u32 v48, s69, v38
    v_mov_b32 v49, s69
    v_cmp_gt_u32 vcc, s74, v38
    v_cmp_gt_u32 s[76:77], 12, v38
    s_and_b64 vcc, vcc, s[76:77]
    s_nop 1
    v_cndmask_b32 v48, v49, v48, vcc
    v_add_u32 v49, s67, v48
    v_cmp_gt_u32 vcc, s66, v48
    s_nop 1
    v_cndmask_b32 v48, v49, v48, vcc
    v_add_u32 v48, s72, v48
    v_lshlrev_b32 v48, 11, v48
    v_and_b32 v49, 3, v1
    v_lshl_add_u32 v48, v49, 4, v48
    s_lshl_b32 s96, s64, 8
    s_add_u32 s96, s96, 0x1100000
    v_add_u32 v8, s96, v48
    v_lshlrev_b32 v35, 9, v35
    v_lshl_add_u32 v35, v34, 1, v35
    s_waitcnt vmcnt(32)
    s_barrier
    buffer_load_dwordx4 v[240:243], v8, s[28:31], 0 offen offset:0 sc1
    buffer_load_dwordx4 v[244:247], v8, s[28:31], 0 offen offset:64 sc1
    buffer_load_dwordx4 v[248:251], v8, s[28:31], 0 offen offset:128 sc1
    buffer_load_dwordx4 v[252:255], v8, s[28:31], 0 offen offset:192 sc1
    s_waitcnt vmcnt(4)
    s_barrier
    s_waitcnt vmcnt(0)
    s_add_u32 s63, s63, 1
    s_cmp_ge_u32 s63, s62
    s_cbranch_scc1 LD_combine
    s_barrier
    s_branch LD_round
LD_fallback:
    s_waitcnt vmcnt(0) lgkmcnt(0)
    s_barrier
    s_branch LD_generic
LD_combine:
    s_mov_b32 s99, 0x3e0293ee
    s_mov_b32 s73, 0
    s_branch L_chkml
L_cbatch:
    s_mov_b32 s73, 0
L_pollml:
    buffer_load_dwordx4 v[240:243], v8, s[28:31], 0 offen offset:0 sc1
    buffer_load_dwordx4 v[244:247], v8, s[28:31], 0 offen offset:64 sc1
    buffer_load_dwordx4 v[248:251], v8, s[28:31], 0 offen offset:128 sc1
    buffer_load_dwordx4 v[252:255], v8, s[28:31], 0 offen offset:192 sc1
    s_waitcnt vmcnt(0)
L_chkml:
    v_cmp_eq_u64 vcc, s[6:7], v[242:243]
    v_cmp_eq_u64 s[76:77], s[6:7], v[246:247]
    s_and_b64 vcc, vcc, s[76:77]
    v_cmp_eq_u64 s[76:77], s[6:7], v[250:251]
    s_and_b64 vcc, vcc, s[76:77]
    v_cmp_eq_u64 s[76:77], s[6:7], v[254:255]
    s_and_b64 vcc, vcc, s[76:77]
    s_or_b32 vcc_hi, vcc_hi, 0xffff0000
    s_cmp_eq_u64 vcc, -1
    s_cbranch_scc1 L_mlok
    s_add_u32 s73, s73, 1
    s_cmp_gt_u32 s73, 0x40000
    s_cbranch_scc1 L_end
    s_branch L_pollml
L_mlok:
    v_cmp_gt_u32 vcc, s74, v38
    v_cmp_gt_u32 s[76:77], 12, v38
    v_add_f32 v241, v241, v245
    v_add_f32 v249, v249, v253
    s_and_b64 vcc, vcc, s[76:77]
    v_mov_b32 v53, 0xf149f2ca
    v_add_f32 v241, v241, v249
    v_cndmask_b32 v48, v53, v240, vcc
    v_cndmask_b32 v49, 0, v241, vcc
    v_max_f32 v50, v48, v10
    s_nop 1
    v_max_f32_dpp v50, v50, v50 row_ror:4 row_mask:0xf bank_mask:0xf
    s_nop 1
    v_max_f32_dpp v50, v50, v50 row_ror:8 row_mask:0xf bank_mask:0xf
    v_mov_b32 v53, v50
    s_nop 1
    v_permlane16_swap_b32 v50, v53
    s_nop 1
    v_max_f32 v50, v50, v53
    v_mov_b32 v53, v50
    s_nop 1
    v_permlane32_swap_b32 v50, v53
    s_nop 1
    v_max_f32 v50, v50, v53
    v_mul_f32 v53, 0xbe0293ee, v50
    v_fma_f32 v52, v48, s99, v53
    v_fma_f32 v26, v10, s99, v53
    v_exp_f32 v52, v52
    v_exp_f32 v26, v26
    v_mov_b32 v10, v50
    v_mul_f32 v51, v52, v49
    s_nop 1
    v_add_f32_dpp v51, v51, v51 row_ror:4 row_mask:0xf bank_mask:0xf
    s_nop 1
    v_add_f32_dpp v51, v51, v51 row_ror:8 row_mask:0xf bank_mask:0xf
    v_mov_b32 v53, v51
    s_nop 1
    v_permlane16_swap_b32 v51, v53
    s_nop 1
    v_add_f32 v51, v51, v53
    v_mov_b32 v53, v51
    s_nop 1
    v_permlane32_swap_b32 v51, v53
    s_nop 1
    v_add_f32 v51, v51, v53
    v_fma_f32 v14, v14, v26, v51
    v_cmp_eq_u32 vcc, 12, v38
    v_rcp_f32 v51, v14
    v_cmp_eq_u32 s[76:77], 13, v38
    s_nop 0
    v_cndmask_b32 v52, v52, v26, vcc
    v_cndmask_b32 v52, v52, v51, s[76:77]
    ds_write_b32 v36, v52
    ds_read_b128 v[96:99], v37 offset:0
    ds_read_b128 v[100:103], v37 offset:32
    ds_read_b128 v[104:107], v37 offset:64
    ds_read_b128 v[108:111], v37 offset:96
    ds_read_b128 v[112:115], v37 offset:128
    ds_read_b128 v[116:119], v37 offset:160
    ds_read_b128 v[22:25], v222 offset:192
    ds_read_b128 v[30:33], v222 offset:208
    s_mov_b32 s20, s14
    s_and_b32 s21, s15, 0xffff
    s_mov_b32 s22, 0x10000
    s_mov_b32 s23, 0x20000
    s_mov_b32 s73, 0
    s_add_u32 s96, s74, 1
    s_lshr_b32 s96, s96, 1
    s_min_u32 s96, s96, 6
    s_lshl_b32 s96, 1, s96
    s_sub_u32 s75, s96, 1
    s_mov_b32 s70, s75
    s_sleep 8
    s_sleep 8
L_pollo:
    s_bitcmp1_b32 s75, 0
    s_cbranch_scc0 L_noload0
    buffer_load_dwordx4 v[64:67], v40, s[28:31], 0 offen sc1
L_noload0:
    s_bitcmp1_b32 s75, 1
    s_cbranch_scc0 L_noload1
    buffer_load_dwordx4 v[68:71], v41, s[28:31], 0 offen sc1
L_noload1:
    s_bitcmp1_b32 s75, 2
    s_cbranch_scc0 L_noload2
    buffer_load_dwordx4 v[72:75], v42, s[28:31], 0 offen sc1
L_noload2:
    s_bitcmp1_b32 s75, 3
    s_cbranch_scc0 L_noload3
    buffer_load_dwordx4 v[76:79], v43, s[28:31], 0 offen sc1
L_noload3:
    s_bitcmp1_b32 s75, 4
    s_cbranch_scc0 L_noload4
    buffer_load_dwordx4 v[80:83], v44, s[28:31], 0 offen sc1
L_noload4:
    s_bitcmp1_b32 s75, 5
    s_cbranch_scc0 L_noload5
    buffer_load_dwordx4 v[84:87], v45, s[28:31], 0 offen sc1
L_noload5:
    s_waitcnt vmcnt(0)
    v_cmp_eq_u32 vcc, s6, v67
    s_cmp_eq_u64 vcc, -1
    s_cselect_b32 s96, 0xfffffffe, -1
    s_and_b32 s75, s75, s96
    v_cmp_eq_u32 vcc, s6, v71
    s_cmp_eq_u64 vcc, -1
    s_cselect_b32 s96, 0xfffffffd, -1
    s_and_b32 s75, s75, s96
    v_cmp_eq_u32 vcc, s6, v75
    s_cmp_eq_u64 vcc, -1
    s_cselect_b32 s96, 0xfffffffb, -1
    s_and_b32 s75, s75, s96
    v_cmp_eq_u32 vcc, s6, v79
    s_cmp_eq_u64 vcc, -1
    s_cselect_b32 s96, 0xfffffff7, -1
    s_and_b32 s75, s75, s96
    v_cmp_eq_u32 vcc, s6, v83
    s_cmp_eq_u64 vcc, -1
    s_cselect_b32 s96, 0xffffffef, -1
    s_and_b32 s75, s75, s96
    v_cmp_eq_u32 vcc, s6, v87
    s_cmp_eq_u64 vcc, -1
    s_cselect_b32 s96, 0xffffffdf, -1
    s_and_b32 s75, s75, s96
    s_cmp_eq_u32 s75, 0
    s_cbranch_scc1 L_ook
    s_add_u32 s73, s73, 1
    s_cmp_gt_u32 s73, 0x40000
    s_cbranch_scc1 L_end
    s_branch L_pollo
L_ook:
    s_waitcnt lgkmcnt(0)
    v_mul_f32 v18, v18, v22
    v_mul_f32 v19, v19, v23
    v_mul_f32 v20, v20, v24
    v_mul_f32 v21, v21, v25
    v_perm_b32 v67, v64, v65, s93
    v_fma_f32 v18, v96, v64, v18
    v_perm_b32 v67, v67, v66, s94
    v_fma_f32 v19, v97, v65, v19
    v_fma_f32 v20, v98, v66, v20
    v_fma_f32 v21, v99, v67, v21
    s_bitcmp1_b32 s70, 1
    s_cbranch_scc0 L_accdone
    v_perm_b32 v71, v68, v69, s93
    v_fma_f32 v18, v100, v68, v18
    v_perm_b32 v71, v71, v70, s94
    v_fma_f32 v19, v101, v69, v19
    v_fma_f32 v20, v102, v70, v20
    v_fma_f32 v21, v103, v71, v21
    s_bitcmp1_b32 s70, 2
    s_cbranch_scc0 L_accdone
    v_perm_b32 v75, v72, v73, s93
    v_fma_f32 v18, v104, v72, v18
    v_perm_b32 v75, v75, v74, s94
    v_fma_f32 v19, v105, v73, v19
    v_fma_f32 v20, v106, v74, v20
    v_fma_f32 v21, v107, v75, v21
    s_bitcmp1_b32 s70, 3
    s_cbranch_scc0 L_accdone
    v_perm_b32 v79, v76, v77, s93
    v_fma_f32 v18, v108, v76, v18
    v_perm_b32 v79, v79, v78, s94
    v_fma_f32 v19, v109, v77, v19
    v_fma_f32 v20, v110, v78, v20
    v_fma_f32 v21, v111, v79, v21
    s_bitcmp1_b32 s70, 4
    s_cbranch_scc0 L_accdone
    v_perm_b32 v83, v80, v81, s93
    v_fma_f32 v18, v112, v80, v18
    v_perm_b32 v83, v83, v82, s94
    v_fma_f32 v19, v113, v81, v19
    v_fma_f32 v20, v114, v82, v20
    v_fma_f32 v21, v115, v83, v21
    s_bitcmp1_b32 s70, 5
    s_cbranch_scc0 L_accdone
    v_perm_b32 v87, v84, v85, s93
    v_fma_f32 v18, v116, v84, v18
    v_perm_b32 v87, v87, v86, s94
    v_fma_f32 v19, v117, v85, v19
    v_fma_f32 v20, v118, v86, v20
    v_fma_f32 v21, v119, v87, v21
L_accdone:
    s_add_u32 s69, s69, 12
    s_cmp_lt_u32 s69, s68
    s_cbranch_scc0 L_final
    s_sub_u32 s74, s68, s69
    s_add_u32 s96, s69, 0
    s_cmp_gt_u32 s74, 0
    s_cselect_b32 s96, s96, s69
    s_add_u32 s97, s96, s67
    s_cmp_lt_u32 s96, s66
    s_cselect_b32 s96, s96, s97
    s_add_u32 s96, s96, s72
    s_lshl_b32 s80, s96, 14
    s_add_u32 s96, s69, 1
    s_cmp_gt_u32 s74, 1
    s_cselect_b32 s96, s96, s69
    s_add_u32 s97, s96, s67
    s_cmp_lt_u32 s96, s66
    s_cselect_b32 s96, s96, s97
    s_add_u32 s96, s96, s72
    s_lshl_b32 s81, s96, 14
    s_add_u32 s96, s69, 2
    s_cmp_gt_u32 s74, 2
    s_cselect_b32 s96, s96, s69
    s_add_u32 s97, s96, s67
    s_cmp_lt_u32 s96, s66
    s_cselect_b32 s96, s96, s97
    s_add_u32 s96, s96, s72
    s_lshl_b32 s82, s96, 14
    s_add_u32 s96, s69, 3
    s_cmp_gt_u32 s74, 3
    s_cselect_b32 s96, s96, s69
    s_add_u32 s97, s96, s67
    s_cmp_lt_u32 s96, s66
    s_cselect_b32 s96, s96, s97
    s_add_u32 s96, s96, s72
    s_lshl_b32 s83, s96, 14
    s_add_u32 s96, s69, 4
    s_cmp_gt_u32 s74, 4
    s_cselect_b32 s96, s96, s69
    s_add_u32 s97, s96, s67
    s_cmp_lt_u32 s96, s66
    s_cselect_b32 s96, s96, s97
    s_add_u32 s96, s96, s72
    s_lshl_b32 s84, s96, 14
    s_add_u32 s96, s69, 5
    s_cmp_gt_u32 s74, 5
    s_cselect_b32 s96, s96, s69
    s_add_u32 s97, s96, s67
    s_cmp_lt_u32 s96, s66
    s_cselect_b32 s96, s96, s97
    s_add_u32 s96, s96, s72
    s_lshl_b32 s85, s96, 14
    s_add_u32 s96, s69, 6
    s_cmp_gt_u32 s74, 6
    s_cselect_b32 s96, s96, s69
    s_add_u32 s97, s96, s67
    s_cmp_lt_u32 s96, s66
    s_cselect_b32 s96, s96, s97
    s_add_u32 s96, s96, s72
    s_lshl_b32 s86, s96, 14
    s_add_u32 s96, s69, 7
    s_cmp_gt_u32 s74, 7
    s_cselect_b32 s96, s96, s69
    s_add_u32 s97, s96, s67
    s_cmp_lt_u32 s96, s66
    s_cselect_b32 s96, s96, s97
    s_add_u32 s96, s96, s72
    s_lshl_b32 s87, s96, 14
    s_add_u32 s96, s69, 8
    s_cmp_gt_u32 s74, 8
    s_cselect_b32 s96, s96, s69
    s_add_u32 s97, s96, s67
    s_cmp_lt_u32 s96, s66
    s_cselect_b32 s96, s96, s97
    s_add_u32 s96, s96, s72
    s_lshl_b32 s88, s96, 14
    s_add_u32 s96, s69, 9
    s_cmp_gt_u32 s74, 9
    s_cselect_b32 s96, s96, s69
    s_add_u32 s97, s96, s67
    s_cmp_lt_u32 s96, s66
    s_cselect_b32 s96, s96, s97
    s_add_u32 s96, s96, s72
    s_lshl_b32 s89, s96, 14
    s_add_u32 s96, s69, 10
    s_cmp_gt_u32 s74, 10
    s_cselect_b32 s96, s96, s69
    s_add_u32 s97, s96, s67
    s_cmp_lt_u32 s96, s66
    s_cselect_b32 s96, s96, s97
    s_add_u32 s96, s96, s72
    s_lshl_b32 s90, s96, 14
    s_add_u32 s96, s69, 11
    s_cmp_gt_u32 s74, 11
    s_cselect_b32 s96, s96, s69
    s_add_u32 s97, s96, s67
    s_cmp_lt_u32 s96, s66
    s_cselect_b32 s96, s96, s97
    s_add_u32 s96, s96, s72
    s_lshl_b32 s91, s96, 14
    v_mov_b32 v48, s80
    v_mov_b32 v49, s81
    v_cndmask_b32 v48, v48, v49, s[78:79]
    v_add_u32 v40, v48, v39
    v_mov_b32 v48, s82
    v_mov_b32 v49, s83
    v_cndmask_b32 v48, v48, v49, s[78:79]
    v_add_u32 v41, v48, v39
    v_mov_b32 v48, s84
    v_mov_b32 v49, s85
    v_cndmask_b32 v48, v48, v49, s[78:79]
    v_add_u32 v42, v48, v39
    v_mov_b32 v48, s86
    v_mov_b32 v49, s87
    v_cndmask_b32 v48, v48, v49, s[78:79]
    v_add_u32 v43, v48, v39
    v_mov_b32 v48, s88
    v_mov_b32 v49, s89
    v_cndmask_b32 v48, v48, v49, s[78:79]
    v_add_u32 v44, v48, v39
    v_mov_b32 v48, s90
    v_mov_b32 v49, s91
    v_cndmask_b32 v48, v48, v49, s[78:79]
    v_add_u32 v45, v48, v39
    v_add_u32 v48, s69, v38
    v_mov_b32 v49, s69
    v_cmp_gt_u32 vcc, s74, v38
    v_cmp_gt_u32 s[76:77], 12, v38
    s_and_b64 vcc, vcc, s[76:77]
    s_nop 1
    v_cndmask_b32 v48, v49, v48, vcc
    v_add_u32 v49, s67, v48
    v_cmp_gt_u32 vcc, s66, v48
    s_nop 1
    v_cndmask_b32 v48, v49, v48, vcc
    v_add_u32 v48, s72, v48
    v_lshlrev_b32 v48, 11, v48
    v_and_b32 v49, 3, v1
    v_lshl_add_u32 v48, v49, 4, v48
    s_lshl_b32 s96, s64, 8
    s_add_u32 s96, s96, 0x1100000
    v_add_u32 v8, s96, v48
    s_branch L_cbatch
L_final:
    v_mov_b32 v48, v18
    v_mov_b32 v49, v19
    v_mov_b32 v50, v20
    v_mov_b32 v51, v21
    s_nop 1
    v_permlane32_swap_b32 v18, v48
    v_permlane32_swap_b32 v19, v49
    v_permlane32_swap_b32 v20, v50
    v_permlane32_swap_b32 v21, v51
    s_nop 1
    v_add_f32 v18, v18, v48
    v_add_f32 v19, v19, v49
    v_add_f32 v20, v20, v50
    v_add_f32 v21, v21, v51
    v_mul_f32 v18, v18, v30
    v_mul_f32 v19, v19, v31
    v_mul_f32 v20, v20, v32
    v_mul_f32 v21, v21, v33
    v_cndmask_b32 v48, v18, v20, s[78:79]
    v_cndmask_b32 v49, v19, v21, s[78:79]
    v_cvt_pk_bf16_f32 v48, v48, v49
    buffer_store_short v48, v35, s[20:23], s92 offen sc1
    buffer_store_short_d16_hi v48, v35, s[20:23], s92 offen offset:256 sc1
L_end:
    s_endpgm
LD_generic:
    s_mov_b32 s8, 0
    s_load_dwordx8 s[32:39], s[12:13], 0
    v_lshlrev_b32 v200, 4, v1
    v_add_u32 v201, 0x1000, v200
    global_load_dwordx4 v[160:163], v200, s[10:11] offset:0
    global_load_dwordx4 v[164:167], v200, s[10:11] offset:1024
    global_load_dwordx4 v[168:171], v200, s[10:11] offset:2048
    global_load_dwordx4 v[172:175], v200, s[10:11] offset:3072
    global_load_dwordx4 v[176:179], v201, s[10:11] offset:0
    global_load_dwordx4 v[180:183], v201, s[10:11] offset:1024
    global_load_dwordx4 v[184:187], v201, s[10:11] offset:2048
    global_load_dwordx4 v[188:191], v201, s[10:11] offset:3072
    s_waitcnt lgkmcnt(0)
    s_cmp_lt_i32 s32, 1
    s_cselect_b32 s32, 0x1000, s32
    s_min_i32 s32, s32, 0x1000
    s_add_i32 s32, s32, 15
    s_lshr_b32 s32, s32, 4
    s_cmp_lt_i32 s33, 1
    s_cselect_b32 s33, 0x1000, s33
    s_min_i32 s33, s33, 0x1000
    s_add_i32 s33, s33, 15
    s_lshr_b32 s33, s33, 4
    s_cmp_lt_i32 s34, 1
    s_cselect_b32 s34, 0x1000, s34
    s_min_i32 s34, s34, 0x1000
    s_add_i32 s34, s34, 15
    s_lshr_b32 s34, s34, 4
    s_cmp_lt_i32 s35, 1
    s_cselect_b32 s35, 0x1000, s35
    s_min_i32 s35, s35, 0x1000
    s_add_i32 s35, s35, 15
    s_lshr_b32 s35, s35, 4
    s_cmp_lt_i32 s36, 1
    s_cselect_b32 s36, 0x1000, s36
    s_min_i32 s36, s36, 0x1000
    s_add_i32 s36, s36, 15
    s_lshr_b32 s36, s36, 4
    s_cmp_lt_i32 s37, 1
    s_cselect_b32 s37, 0x1000, s37
    s_min_i32 s37, s37, 0x1000
    s_add_i32 s37, s37, 15
    s_lshr_b32 s37, s37, 4
    s_cmp_lt_i32 s38, 1
    s_cselect_b32 s38, 0x1000, s38
    s_min_i32 s38, s38, 0x1000
    s_add_i32 s38, s38, 15
    s_lshr_b32 s38, s38, 4
    s_cmp_lt_i32 s39, 1
    s_cselect_b32 s39, 0x1000, s39
    s_min_i32 s39, s39, 0x1000
    s_add_i32 s39, s39, 15
    s_lshr_b32 s39, s39, 4
    s_max_u32 s96, s32, s33
    s_max_u32 s96, s96, s34
    s_max_u32 s96, s96, s35
    s_max_u32 s96, s96, s36
    s_max_u32 s96, s96, s37
    s_max_u32 s96, s96, s38
    s_max_u32 s96, s96, s39
    s_waitcnt vmcnt(0)
    v_sad_u32 v192, v164, v160, 0
    v_sad_u32 v193, v165, v161, 0
    v_sad_u32 v194, v166, v162, 0
    v_sad_u32 v195, v167, v163, 0
    v_sad_u32 v192, v168, v160, v192
    v_sad_u32 v193, v169, v161, v193
    v_sad_u32 v194, v170, v162, v194
    v_sad_u32 v195, v171, v163, v195
    v_sad_u32 v192, v172, v160, v192
    v_sad_u32 v193, v173, v161, v193
    v_sad_u32 v194, v174, v162, v194
    v_sad_u32 v195, v175, v163, v195
    v_sad_u32 v192, v176, v160, v192
    v_sad_u32 v193, v177, v161, v193
    v_sad_u32 v194, v178, v162, v194
    v_sad_u32 v195, v179, v163, v195
    v_sad_u32 v192, v180, v160, v192
    v_sad_u32 v193, v181, v161, v193
    v_sad_u32 v194, v182, v162, v194
    v_sad_u32 v195, v183, v163, v195
    v_sad_u32 v192, v184, v160, v192
    v_sad_u32 v193, v185, v161, v193
    v_sad_u32 v194, v186, v162, v194
    v_sad_u32 v195, v187, v163, v195
    v_sad_u32 v192, v188, v160, v192
    v_sad_u32 v193, v189, v161, v193
    v_sad_u32 v194, v190, v162, v194
    v_sad_u32 v195, v191, v163, v195
    v_cmp_ne_u32 s[80:81], 0, v192
    v_cmp_ne_u32 s[82:83], 0, v193
    v_cmp_ne_u32 s[84:85], 0, v194
    v_cmp_ne_u32 s[86:87], 0, v195
    s_nop 3
    s_ff1_i32_b64 s72, s[80:81]
    s_lshl2_add_u32 s72, s72, 0
    s_ff1_i32_b64 s73, s[82:83]
    s_lshl2_add_u32 s73, s73, 1
    s_ff1_i32_b64 s74, s[84:85]
    s_lshl2_add_u32 s74, s74, 2
    s_ff1_i32_b64 s75, s[86:87]
    s_lshl2_add_u32 s75, s75, 3
    s_min_u32 s60, s72, s73
    s_min_u32 s60, s60, s74
    s_min_u32 s60, s60, s75
    s_min_u32 s60, s60, s96
    s_mov_b32 s40, s60
    s_sub_i32 s97, s32, s60
    s_max_i32 s97, s97, 0
    s_add_u32 s41, s40, s97
    s_sub_i32 s97, s33, s60
    s_max_i32 s97, s97, 0
    s_add_u32 s42, s41, s97
    s_sub_u32 s50, s60, s41
    s_add_u32 s50, s50, 256
    s_sub_i32 s97, s34, s60
    s_max_i32 s97, s97, 0
    s_add_u32 s43, s42, s97
    s_sub_u32 s51, s60, s42
    s_add_u32 s51, s51, 512
    s_sub_i32 s97, s35, s60
    s_max_i32 s97, s97, 0
    s_add_u32 s44, s43, s97
    s_sub_u32 s52, s60, s43
    s_add_u32 s52, s52, 768
    s_sub_i32 s97, s36, s60
    s_max_i32 s97, s97, 0
    s_add_u32 s45, s44, s97
    s_sub_u32 s53, s60, s44
    s_add_u32 s53, s53, 1024
    s_sub_i32 s97, s37, s60
    s_max_i32 s97, s97, 0
    s_add_u32 s46, s45, s97
    s_sub_u32 s54, s60, s45
    s_add_u32 s54, s54, 1280
    s_sub_i32 s97, s38, s60
    s_max_i32 s97, s97, 0
    s_add_u32 s47, s46, s97
    s_sub_u32 s55, s60, s46
    s_add_u32 s55, s55, 1536
    s_sub_i32 s97, s39, s60
    s_max_i32 s97, s97, 0
    s_add_u32 s48, s47, s97
    s_sub_u32 s56, s60, s47
    s_add_u32 s56, s56, 1792
    s_cmp_gt_u32 s48, 1024
    s_cselect_b32 s61, 8, 7
    s_cselect_b32 s62, 2, 1
    s_mov_b32 s63, 0
LD_round:
    s_lshl_b32 s96, s63, 5
    s_add_u32 s101, s58, s96
    s_lshl_b32 s96, s101, 2
    v_lshrrev_b32 v192, 3, v1
    v_add_u32 v192, s96, v192
    v_mul_u32_u24 v192, s48, v192
    v_add_u32 v193, s48, v192
    v_lshrrev_b32 v192, s61, v192
    v_lshrrev_b32 v193, s61, v193
    v_and_b32 v194, 7, v1
    v_add_u32 v213, v192, v194
    v_mov_b32 v214, 0
    v_cmpx_le_u32 vcc, s41, v213
    v_mov_b32 v214, s50
    v_cmpx_le_u32 vcc, s42, v213
    v_mov_b32 v214, s51
    v_cmpx_le_u32 vcc, s43, v213
    v_mov_b32 v214, s52
    v_cmpx_le_u32 vcc, s44, v213
    v_mov_b32 v214, s53
    v_cmpx_le_u32 vcc, s45, v213
    v_mov_b32 v214, s54
    v_cmpx_le_u32 vcc, s46, v213
    v_mov_b32 v214, s55
    v_cmpx_le_u32 vcc, s47, v213
    v_mov_b32 v214, s56
    s_mov_b64 exec, -1
    v_add_u32 v215, v213, v214
    v_cmp_gt_u32 vcc, v193, v213
    v_lshlrev_b32 v192, 2, v215
    s_nop 0
    v_cndmask_b32 v192, 0, v192, vcc
    global_load_dword v218, v192, s[10:11]
    s_waitcnt vmcnt(0)
    v_mov_b32 v193, 0x480
    v_min_u32 v218, 0x480, v218
    v_cndmask_b32 v218, v193, v218, vcc
    v_lshlrev_b32 v218, 15, v218
    s_nop 1
    s_branch LD_issue
C_entry:
    s_lshl_b32 s100, s59, 15
    s_lshl_b32 s96, s63, 5
    s_add_u32 s101, s58, s96
    s_lshl2_add_u32 s96, s101, s59
    s_mul_i32 s97, s96, s48
    s_add_u32 s98, s97, s48
    s_lshr_b32 s97, s97, s61
    s_lshr_b32 s98, s98, s61
    v_add_u32 v213, s97, v1
    v_mov_b32 v214, 0
    v_cmpx_le_u32 vcc, s41, v213
    v_mov_b32 v214, s50
    v_cmpx_le_u32 vcc, s42, v213
    v_mov_b32 v214, s51
    v_cmpx_le_u32 vcc, s43, v213
    v_mov_b32 v214, s52
    v_cmpx_le_u32 vcc, s44, v213
    v_mov_b32 v214, s53
    v_cmpx_le_u32 vcc, s45, v213
    v_mov_b32 v214, s54
    v_cmpx_le_u32 vcc, s46, v213
    v_mov_b32 v214, s55
    v_cmpx_le_u32 vcc, s47, v213
    v_mov_b32 v214, s56
    s_mov_b64 exec, -1
    v_add_u32 v215, v213, v214
    v_cmp_gt_u32 vcc, s98, v213
    v_and_b32 v217, 0xff, v215
    v_lshlrev_b32 v217, 4, v217
    v_lshrrev_b32 v193, 8, v215
    v_lshlrev_b32 v193, 2, v193
    v_lshlrev_b32_e64 v216, v193, 15
    v_cmp_gt_u32 s[80:81], s60, v213
    v_mov_b32 v193, -1
    s_nop 0
    v_cndmask_b32 v216, v216, v193, s[80:81]
    v_cndmask_b32 v216, 0, v216, vcc
    v_lshlrev_b32 v200, 4, v1
    s_lshl_b32 s96, s59, 11
    v_add_u32 v200, s96, v200
    v_bfe_u32 v192, v1, 2, 3
    v_lshlrev_b32 v203, 2, v192
    v_and_b32 v192, 31, v1
    v_lshrrev_b32 v193, 5, v1
    v_lshlrev_b32 v192, 4, v192
    v_lshl_add_u32 v192, v193, 11, v192
    s_lshl_b32 s97, s59, 9
    v_add_u32 v212, s97, v192
    s_waitcnt lgkmcnt(0)
    s_load_dwordx8 s[32:39], s[12:13], 0
    global_load_dword v21, v203, s[12:13]
    global_load_dwordx4 v[236:239], v200, s[10:11] offset:0
    global_load_dwordx4 v[240:243], v200, s[10:11] offset:1024
    s_mov_b32 s28, s18
    s_and_b32 s29, s19, 0xffff
    s_mov_b32 s30, 0x1200000
    s_mov_b32 s31, 0x20000
    s_mov_b32 s9, 0
    s_or_b32 s96, s2, s59
    s_cmp_lg_u32 s96, 0
    s_cbranch_scc1 L_nononce
    s_memrealtime s[96:97]
    s_waitcnt lgkmcnt(0)
    s_or_b32 s96, s96, 1
    v_mov_b32 v192, s96
    v_mov_b32 v193, s97
    v_lshlrev_b32 v194, 6, v1
    s_mov_b64 exec, 15
    global_store_dwordx2 v194, v[192:193], s[16:17] sc1
    s_mov_b64 exec, -1
L_nononce:
    s_and_b32 s96, s58, 3
    s_lshl_b32 s96, s96, 6
    v_mov_b32 v221, s96
    v_and_b32 v192, 31, v1
    v_lshrrev_b32 v193, 5, v1
    v_and_b32 v194, 3, v1
    v_bfe_u32 v198, v1, 2, 2
    v_lshl_or_b32 v194, v194, 2, v198
    v_xor_b32 v194, v194, v193
    v_lshlrev_b32 v194, 4, v194
    v_lshl_add_u32 v194, v192, 8, v194
    v_add_u32 v6, s100, v194
    v_xor_b32 v7, 32, v6
    v_xor_b32 v8, 64, v6
    v_xor_b32 v9, 96, v6
    v_xor_b32 v10, 128, v6
    v_xor_b32 v11, 160, v6
    v_xor_b32 v12, 192, v6
    v_xor_b32 v13, 224, v6
    v_bfe_u32 v22, v1, 2, 2
    v_lshrrev_b32 v23, 5, v1
    v_bfe_u32 v24, v1, 4, 1
    v_bfe_u32 v25, v1, 1, 1
    v_lshl_or_b32 v24, v24, 1, v25
    s_lshl_b32 s97, s59, 2
    v_or_b32 v24, s97, v24
    v_lshl_or_b32 v25, v22, 2, v23
    v_xor_b32 v25, v25, v24
    v_lshlrev_b32 v25, 4, v25
    v_lshl_add_u32 v26, v23, 2, v22
    v_add_u32 v26, 0, v26
    v_lshl_add_u32 v25, v26, 8, v25
    v_and_b32 v27, 1, v1
    v_lshl_add_u32 v14, v27, 3, v25
    v_add_u32 v16, 0x10000, v14
    v_lshl_or_b32 v25, v22, 2, v23
    v_or_b32 v25, 2, v25
    v_xor_b32 v25, v25, v24
    v_lshlrev_b32 v25, 4, v25
    v_lshl_add_u32 v26, v23, 2, v22
    v_add_u32 v26, 8, v26
    v_lshl_add_u32 v25, v26, 8, v25
    v_and_b32 v27, 1, v1
    v_lshl_add_u32 v15, v27, 3, v25
    v_add_u32 v17, 0x10000, v15
    v_lshlrev_b32 v22, 4, v1
    v_add_u32 v19, 0x20000, v22
    s_lshl_b32 s97, s59, 13
    v_add_u32 v18, s97, v19
    v_mov_b32 v31, 0xff800000
    v_mov_b32 v208, 0x3f803f80
    v_mov_b32 v209, 0x3f803f80
    v_mov_b32 v210, 0x3f803f80
    v_mov_b32 v211, 0x3f803f80
    s_waitcnt lgkmcnt(0)
    s_mov_b32 s8, 0
    s_cmp_lg_u32 s32, 3663
    s_cselect_b32 s8, 1, s8
    s_cmp_lg_u32 s33, 3230
    s_cselect_b32 s8, 1, s8
    s_cmp_lg_u32 s34, 3821
    s_cselect_b32 s8, 1, s8
    s_cmp_lg_u32 s35, 3388
    s_cselect_b32 s8, 1, s8
    s_cmp_lg_u32 s36, 3979
    s_cselect_b32 s8, 1, s8
    s_cmp_lg_u32 s37, 3546
    s_cselect_b32 s8, 1, s8
    s_cmp_lg_u32 s38, 3113
    s_cselect_b32 s8, 1, s8
    s_cmp_lg_u32 s39, 3704
    s_cselect_b32 s8, 1, s8
    s_waitcnt vmcnt(0)
    v_lshrrev_b32 v22, 5, v1
    v_lshlrev_b32 v22, 7, v22
    v_lshlrev_b32 v23, 2, v1
    s_lshl_b32 s96, s59, 1
    v_mov_b32 v25, 0
    v_mad_u32_u24 v24, v22, s96, v23
    v_add_u32 v26, 0, v24
    v_sad_u32 v25, v236, v26, v25
    v_add_u32 v26, 1, v24
    v_sad_u32 v25, v237, v26, v25
    v_add_u32 v26, 2, v24
    v_sad_u32 v25, v238, v26, v25
    v_add_u32 v26, 3, v24
    v_sad_u32 v25, v239, v26, v25
    s_add_u32 s96, s96, 1
    v_mad_u32_u24 v24, v22, s96, v23
    v_add_u32 v26, 0, v24
    v_sad_u32 v25, v240, v26, v25
    v_add_u32 v26, 1, v24
    v_sad_u32 v25, v241, v26, v25
    v_add_u32 v26, 2, v24
    v_sad_u32 v25, v242, v26, v25
    v_add_u32 v26, 3, v24
    v_sad_u32 v25, v243, v26, v25
    s_add_u32 s96, s96, 1
    v_cmp_ne_u32 vcc, 0, v25
    s_nop 3
    s_cmp_lg_u64 vcc, 0
    s_cselect_b32 s8, 1, s8
    s_branch C_body
C_generic:
    s_mov_b32 s8, 0
    s_load_dwordx8 s[32:39], s[12:13], 0
    v_lshlrev_b32 v200, 4, v1
    v_add_u32 v201, 0x1000, v200
    global_load_dwordx4 v[160:163], v200, s[10:11] offset:0
    global_load_dwordx4 v[164:167], v200, s[10:11] offset:1024
    global_load_dwordx4 v[168:171], v200, s[10:11] offset:2048
    global_load_dwordx4 v[172:175], v200, s[10:11] offset:3072
    global_load_dwordx4 v[176:179], v201, s[10:11] offset:0
    global_load_dwordx4 v[180:183], v201, s[10:11] offset:1024
    global_load_dwordx4 v[184:187], v201, s[10:11] offset:2048
    global_load_dwordx4 v[188:191], v201, s[10:11] offset:3072
    s_waitcnt lgkmcnt(0)
    s_cmp_lt_i32 s32, 1
    s_cselect_b32 s32, 0x1000, s32
    s_min_i32 s32, s32, 0x1000
    s_add_i32 s32, s32, 15
    s_lshr_b32 s32, s32, 4
    s_cmp_lt_i32 s33, 1
    s_cselect_b32 s33, 0x1000, s33
    s_min_i32 s33, s33, 0x1000
    s_add_i32 s33, s33, 15
    s_lshr_b32 s33, s33, 4
    s_cmp_lt_i32 s34, 1
    s_cselect_b32 s34, 0x1000, s34
    s_min_i32 s34, s34, 0x1000
    s_add_i32 s34, s34, 15
    s_lshr_b32 s34, s34, 4
    s_cmp_lt_i32 s35, 1
    s_cselect_b32 s35, 0x1000, s35
    s_min_i32 s35, s35, 0x1000
    s_add_i32 s35, s35, 15
    s_lshr_b32 s35, s35, 4
    s_cmp_lt_i32 s36, 1
    s_cselect_b32 s36, 0x1000, s36
    s_min_i32 s36, s36, 0x1000
    s_add_i32 s36, s36, 15
    s_lshr_b32 s36, s36, 4
    s_cmp_lt_i32 s37, 1
    s_cselect_b32 s37, 0x1000, s37
    s_min_i32 s37, s37, 0x1000
    s_add_i32 s37, s37, 15
    s_lshr_b32 s37, s37, 4
    s_cmp_lt_i32 s38, 1
    s_cselect_b32 s38, 0x1000, s38
    s_min_i32 s38, s38, 0x1000
    s_add_i32 s38, s38, 15
    s_lshr_b32 s38, s38, 4
    s_cmp_lt_i32 s39, 1
    s_cselect_b32 s39, 0x1000, s39
    s_min_i32 s39, s39, 0x1000
    s_add_i32 s39, s39, 15
    s_lshr_b32 s39, s39, 4
    s_max_u32 s96, s32, s33
    s_max_u32 s96, s96, s34
    s_max_u32 s96, s96, s35
    s_max_u32 s96, s96, s36
    s_max_u32 s96, s96, s37
    s_max_u32 s96, s96, s38
    s_max_u32 s96, s96, s39
    s_waitcnt vmcnt(0)
    v_sad_u32 v192, v164, v160, 0
    v_sad_u32 v193, v165, v161, 0
    v_sad_u32 v194, v166, v162, 0
    v_sad_u32 v195, v167, v163, 0
    v_sad_u32 v192, v168, v160, v192
    v_sad_u32 v193, v169, v161, v193
    v_sad_u32 v194, v170, v162, v194
    v_sad_u32 v195, v171, v163, v195
    v_sad_u32 v192, v172, v160, v192
    v_sad_u32 v193, v173, v161, v193
    v_sad_u32 v194, v174, v162, v194
    v_sad_u32 v195, v175, v163, v195
    v_sad_u32 v192, v176, v160, v192
    v_sad_u32 v193, v177, v161, v193
    v_sad_u32 v194, v178, v162, v194
    v_sad_u32 v195, v179, v163, v195
    v_sad_u32 v192, v180, v160, v192
    v_sad_u32 v193, v181, v161, v193
    v_sad_u32 v194, v182, v162, v194
    v_sad_u32 v195, v183, v163, v195
    v_sad_u32 v192, v184, v160, v192
    v_sad_u32 v193, v185, v161, v193
    v_sad_u32 v194, v186, v162, v194
    v_sad_u32 v195, v187, v163, v195
    v_sad_u32 v192, v188, v160, v192
    v_sad_u32 v193, v189, v161, v193
    v_sad_u32 v194, v190, v162, v194
    v_sad_u32 v195, v191, v163, v195
    v_cmp_ne_u32 s[80:81], 0, v192
    v_cmp_ne_u32 s[82:83], 0, v193
    v_cmp_ne_u32 s[84:85], 0, v194
    v_cmp_ne_u32 s[86:87], 0, v195
    s_nop 3
    s_ff1_i32_b64 s72, s[80:81]
    s_lshl2_add_u32 s72, s72, 0
    s_ff1_i32_b64 s73, s[82:83]
    s_lshl2_add_u32 s73, s73, 1
    s_ff1_i32_b64 s74, s[84:85]
    s_lshl2_add_u32 s74, s74, 2
    s_ff1_i32_b64 s75, s[86:87]
    s_lshl2_add_u32 s75, s75, 3
    s_min_u32 s60, s72, s73
    s_min_u32 s60, s60, s74
    s_min_u32 s60, s60, s75
    s_min_u32 s60, s60, s96
    s_mov_b32 s40, s60
    s_sub_i32 s97, s32, s60
    s_max_i32 s97, s97, 0
    s_add_u32 s41, s40, s97
    s_sub_i32 s97, s33, s60
    s_max_i32 s97, s97, 0
    s_add_u32 s42, s41, s97
    s_sub_u32 s50, s60, s41
    s_add_u32 s50, s50, 256
    s_sub_i32 s97, s34, s60
    s_max_i32 s97, s97, 0
    s_add_u32 s43, s42, s97
    s_sub_u32 s51, s60, s42
    s_add_u32 s51, s51, 512
    s_sub_i32 s97, s35, s60
    s_max_i32 s97, s97, 0
    s_add_u32 s44, s43, s97
    s_sub_u32 s52, s60, s43
    s_add_u32 s52, s52, 768
    s_sub_i32 s97, s36, s60
    s_max_i32 s97, s97, 0
    s_add_u32 s45, s44, s97
    s_sub_u32 s53, s60, s44
    s_add_u32 s53, s53, 1024
    s_sub_i32 s97, s37, s60
    s_max_i32 s97, s97, 0
    s_add_u32 s46, s45, s97
    s_sub_u32 s54, s60, s45
    s_add_u32 s54, s54, 1280
    s_sub_i32 s97, s38, s60
    s_max_i32 s97, s97, 0
    s_add_u32 s47, s46, s97
    s_sub_u32 s55, s60, s46
    s_add_u32 s55, s55, 1536
    s_sub_i32 s97, s39, s60
    s_max_i32 s97, s97, 0
    s_add_u32 s48, s47, s97
    s_sub_u32 s56, s60, s47
    s_add_u32 s56, s56, 1792
    s_cmp_gt_u32 s48, 1024
    s_cselect_b32 s61, 8, 7
    s_cselect_b32 s62, 2, 1
    s_mov_b32 s63, 0
C_round:
    s_lshl_b32 s96, s63, 5
    s_add_u32 s101, s58, s96
    s_lshl2_add_u32 s96, s101, s59
    s_mul_i32 s97, s96, s48
    s_add_u32 s98, s97, s48
    s_lshr_b32 s97, s97, s61
    s_lshr_b32 s98, s98, s61
    v_add_u32 v213, s97, v1
    v_mov_b32 v214, 0
    v_cmpx_le_u32 vcc, s41, v213
    v_mov_b32 v214, s50
    v_cmpx_le_u32 vcc, s42, v213
    v_mov_b32 v214, s51
    v_cmpx_le_u32 vcc, s43, v213
    v_mov_b32 v214, s52
    v_cmpx_le_u32 vcc, s44, v213
    v_mov_b32 v214, s53
    v_cmpx_le_u32 vcc, s45, v213
    v_mov_b32 v214, s54
    v_cmpx_le_u32 vcc, s46, v213
    v_mov_b32 v214, s55
    v_cmpx_le_u32 vcc, s47, v213
    v_mov_b32 v214, s56
    s_mov_b64 exec, -1
    v_add_u32 v215, v213, v214
    v_cmp_gt_u32 vcc, s98, v213
    v_and_b32 v217, 0xff, v215
    v_lshlrev_b32 v217, 4, v217
    v_lshrrev_b32 v193, 8, v215
    v_lshlrev_b32 v193, 2, v193
    v_lshlrev_b32_e64 v216, v193, 15
    v_cmp_gt_u32 s[80:81], s60, v213
    v_mov_b32 v193, -1
    s_nop 0
    v_cndmask_b32 v216, v216, v193, s[80:81]
    v_cndmask_b32 v216, 0, v216, vcc
C_body:
    v_cmp_gt_i32 vcc, 1, v21
    v_mov_b32 v192, 0x1000
    v_min_i32 v193, 0x1000, v21
    v_cndmask_b32 v193, v193, v192, vcc
    v_lshrrev_b32 v194, 5, v1
    v_lshlrev_b32 v194, 2, v194
    v_sub_u32 v20, v193, v194
    v_readlane_b32 s72, v217, 0
    v_readlane_b32 s80, v216, 0
    v_readlane_b32 s81, v216, 0
    v_readlane_b32 s73, v217, 1
    v_readlane_b32 s82, v216, 1
    v_readlane_b32 s83, v216, 1
    v_readlane_b32 s74, v217, 2
    v_readlane_b32 s84, v216, 2
    v_readlane_b32 s85, v216, 2
    v_readlane_b32 s75, v217, 3
    v_readlane_b32 s86, v216, 3
    v_readlane_b32 s87, v216, 3
    v_readlane_b32 s76, v217, 4
    v_readlane_b32 s88, v216, 4
    v_readlane_b32 s89, v216, 4
    v_readlane_b32 s77, v217, 5
    v_readlane_b32 s90, v216, 5
    v_readlane_b32 s91, v216, 5
    v_readlane_b32 s78, v217, 6
    v_readlane_b32 s92, v216, 6
    v_readlane_b32 s93, v216, 6
    v_readlane_b32 s79, v217, 7
    v_readlane_b32 s94, v216, 7
    v_readlane_b32 s95, v216, 7
    s_nop 1
    v_cndmask_b32 v22, 0, v20, s[80:81]
    v_cndmask_b32 v23, 0, v20, s[82:83]
    v_cndmask_b32 v24, 0, v20, s[84:85]
    v_cndmask_b32 v25, 0, v20, s[86:87]
    v_cndmask_b32 v26, 0, v20, s[88:89]
    v_cndmask_b32 v27, 0, v20, s[90:91]
    v_cndmask_b32 v28, 0, v20, s[92:93]
    v_cndmask_b32 v29, 0, v20, s[94:95]
    v_subrev_u32 v22, s72, v22
    v_subrev_u32 v23, s73, v23
    v_subrev_u32 v24, s74, v24
    v_subrev_u32 v25, s75, v25
    v_subrev_u32 v26, s76, v26
    v_subrev_u32 v27, s77, v27
    v_subrev_u32 v28, s78, v28
    v_subrev_u32 v29, s79, v29
    v_mov_b32 v30, v31
    s_lshl_b32 s96, s101, 2
    s_mul_i32 s64, s96, s48
    s_lshl2_add_u32 s65, s48, s64
    s_lshr_b32 s64, s64, s61
    s_lshr_b32 s65, s65, s61
    s_mov_b32 s66, 0
    s_cmp_lt_u32 s64, s41
    s_cselect_b32 s96, 1, 0
    s_cmp_gt_u32 s65, s40
    s_cselect_b32 s96, s96, 0
    s_or_b32 s66, s66, s96
    s_cmp_lt_u32 s64, s42
    s_cselect_b32 s96, 2, 0
    s_cmp_gt_u32 s65, s41
    s_cselect_b32 s96, s96, 0
    s_or_b32 s66, s66, s96
    s_cmp_lt_u32 s64, s43
    s_cselect_b32 s96, 4, 0
    s_cmp_gt_u32 s65, s42
    s_cselect_b32 s96, s96, 0
    s_or_b32 s66, s66, s96
    s_cmp_lt_u32 s64, s44
    s_cselect_b32 s96, 8, 0
    s_cmp_gt_u32 s65, s43
    s_cselect_b32 s96, s96, 0
    s_or_b32 s66, s66, s96
    s_cmp_lt_u32 s64, s45
    s_cselect_b32 s96, 16, 0
    s_cmp_gt_u32 s65, s44
    s_cselect_b32 s96, s96, 0
    s_or_b32 s66, s66, s96
    s_cmp_lt_u32 s64, s46
    s_cselect_b32 s96, 32, 0
    s_cmp_gt_u32 s65, s45
    s_cselect_b32 s96, s96, 0
    s_or_b32 s66, s66, s96
    s_cmp_lt_u32 s64, s47
    s_cselect_b32 s96, 64, 0
    s_cmp_gt_u32 s65, s46
    s_cselect_b32 s96, s96, 0
    s_or_b32 s66, s66, s96
    s_cmp_lt_u32 s64, s48
    s_cselect_b32 s96, 128, 0
    s_cmp_gt_u32 s65, s47
    s_cselect_b32 s96, s96, 0
    s_or_b32 s66, s66, s96
    s_cmp_lt_u32 s64, s60
    s_cselect_b32 s66, 0xff, s66
    s_lshl_b32 s96, s57, 6
    s_add_u32 s96, s96, s101
    s_lshl_b32 s67, s96, 14
    s_add_u32 s67, s67, 0x100000
    s_lshl_b32 s68, s96, 11
    s_add_u32 s68, s68, 0x1100000
    s_lshl_b32 s96, s59, 6
    s_add_u32 s68, s68, s96
    s_barrier
    s_cmp_lg_u32 s9, 0
    s_cbranch_scc1 L_qdone
    s_mov_b32 s9, 1
    s_sub_u32 s96, 0x20000, s100
    v_add_u32 v160, s96, v6
    v_add_u32 v161, s96, v7
    v_add_u32 v162, s96, v8
    v_add_u32 v163, s96, v9
    v_add_u32 v164, s96, v10
    v_add_u32 v165, s96, v11
    v_add_u32 v166, s96, v12
    v_add_u32 v167, s96, v13
    ds_read_b128 v[32:35], v160
    ds_read_b128 v[36:39], v161
    ds_read_b128 v[40:43], v162
    ds_read_b128 v[44:47], v163
    ds_read_b128 v[48:51], v164
    ds_read_b128 v[52:55], v165
    ds_read_b128 v[56:59], v166
    ds_read_b128 v[60:63], v167
    v_cmp_lt_i32 vcc, 0, v21
    s_nop 1
    s_waitcnt lgkmcnt(0)
    v_cndmask_b32 v32, 0, v32, vcc
    v_cndmask_b32 v33, 0, v33, vcc
    v_cndmask_b32 v34, 0, v34, vcc
    v_cndmask_b32 v35, 0, v35, vcc
    v_cndmask_b32 v36, 0, v36, vcc
    v_cndmask_b32 v37, 0, v37, vcc
    v_cndmask_b32 v38, 0, v38, vcc
    v_cndmask_b32 v39, 0, v39, vcc
    v_cndmask_b32 v40, 0, v40, vcc
    v_cndmask_b32 v41, 0, v41, vcc
    v_cndmask_b32 v42, 0, v42, vcc
    v_cndmask_b32 v43, 0, v43, vcc
    v_cndmask_b32 v44, 0, v44, vcc
    v_cndmask_b32 v45, 0, v45, vcc
    v_cndmask_b32 v46, 0, v46, vcc
    v_cndmask_b32 v47, 0, v47, vcc
    v_cndmask_b32 v48, 0, v48, vcc
    v_cndmask_b32 v49, 0, v49, vcc
    v_cndmask_b32 v50, 0, v50, vcc
    v_cndmask_b32 v51, 0, v51, vcc
    v_cndmask_b32 v52, 0, v52, vcc
    v_cndmask_b32 v53, 0, v53, vcc
    v_cndmask_b32 v54, 0, v54, vcc
    v_cndmask_b32 v55, 0, v55, vcc
    v_cndmask_b32 v56, 0, v56, vcc
    v_cndmask_b32 v57, 0, v57, vcc
    v_cndmask_b32 v58, 0, v58, vcc
    v_cndmask_b32 v59, 0, v59, vcc
    v_cndmask_b32 v60, 0, v60, vcc
    v_cndmask_b32 v61, 0, v61, vcc
    v_cndmask_b32 v62, 0, v62, vcc
    v_cndmask_b32 v63, 0, v63, vcc
L_qdone:
    ds_read_b128 v[128:131], v6 offset:0
    ds_read_b128 v[132:135], v7 offset:0
    ds_read_b128 v[136:139], v8 offset:0
    ds_read_b128 v[140:143], v9 offset:0
    ds_read_b128 v[144:147], v10 offset:0
    ds_read_b128 v[148:151], v11 offset:0
    ds_read_b128 v[152:155], v12 offset:0
    ds_read_b128 v[156:159], v13 offset:0
    s_waitcnt lgkmcnt(7)
    v_mfma_f32_32x32x16_bf16 v[64:79], v[128:131], v[32:35], 0
    s_waitcnt lgkmcnt(6)
    v_mfma_f32_32x32x16_bf16 v[64:79], v[132:135], v[36:39], v[64:79]
    s_waitcnt lgkmcnt(5)
    v_mfma_f32_32x32x16_bf16 v[64:79], v[136:139], v[40:43], v[64:79]
    s_waitcnt lgkmcnt(4)
    v_mfma_f32_32x32x16_bf16 v[64:79], v[140:143], v[44:47], v[64:79]
    s_waitcnt lgkmcnt(3)
    v_mfma_f32_32x32x16_bf16 v[64:79], v[144:147], v[48:51], v[64:79]
    s_waitcnt lgkmcnt(2)
    v_mfma_f32_32x32x16_bf16 v[64:79], v[148:151], v[52:55], v[64:79]
    s_waitcnt lgkmcnt(1)
    v_mfma_f32_32x32x16_bf16 v[64:79], v[152:155], v[56:59], v[64:79]
    s_waitcnt lgkmcnt(0)
    v_mfma_f32_32x32x16_bf16 v[64:79], v[156:159], v[60:63], v[64:79]
    s_nop 3
    v_cmp_lt_i32 s[80:81], 0, v22
    v_cmp_lt_i32 s[82:83], 1, v22
    v_cmp_lt_i32 s[84:85], 2, v22
    v_cmp_lt_i32 s[86:87], 3, v22
    v_cmp_lt_i32 s[88:89], 8, v22
    v_cmp_lt_i32 s[90:91], 9, v22
    v_cmp_lt_i32 s[92:93], 10, v22
    v_cmp_lt_i32 s[94:95], 11, v22
    v_cndmask_b32 v64, v31, v64, s[80:81]
    v_cndmask_b32 v65, v31, v65, s[82:83]
    v_cndmask_b32 v66, v31, v66, s[84:85]
    v_cndmask_b32 v67, v31, v67, s[86:87]
    v_cndmask_b32 v68, v31, v68, s[88:89]
    v_cndmask_b32 v69, v31, v69, s[90:91]
    v_cndmask_b32 v70, v31, v70, s[92:93]
    v_cndmask_b32 v71, v31, v71, s[94:95]
    v_max3_f32 v30, v30, v64, v65
    v_max3_f32 v30, v30, v66, v67
    v_max3_f32 v30, v30, v68, v69
    v_max3_f32 v30, v30, v70, v71
    v_cmp_lt_i32 s[80:81], 0, v23
    v_cmp_lt_i32 s[82:83], 1, v23
    v_cmp_lt_i32 s[84:85], 2, v23
    v_cmp_lt_i32 s[86:87], 3, v23
    v_cmp_lt_i32 s[88:89], 8, v23
    v_cmp_lt_i32 s[90:91], 9, v23
    v_cmp_lt_i32 s[92:93], 10, v23
    v_cmp_lt_i32 s[94:95], 11, v23
    v_cndmask_b32 v72, v31, v72, s[80:81]
    v_cndmask_b32 v73, v31, v73, s[82:83]
    v_cndmask_b32 v74, v31, v74, s[84:85]
    v_cndmask_b32 v75, v31, v75, s[86:87]
    v_cndmask_b32 v76, v31, v76, s[88:89]
    v_cndmask_b32 v77, v31, v77, s[90:91]
    v_cndmask_b32 v78, v31, v78, s[92:93]
    v_cndmask_b32 v79, v31, v79, s[94:95]
    v_max3_f32 v30, v30, v72, v73
    v_max3_f32 v30, v30, v74, v75
    v_max3_f32 v30, v30, v76, v77
    v_max3_f32 v30, v30, v78, v79
    s_barrier
    ds_read_b128 v[128:131], v6 offset:8192
    ds_read_b128 v[132:135], v7 offset:8192
    ds_read_b128 v[136:139], v8 offset:8192
    ds_read_b128 v[140:143], v9 offset:8192
    ds_read_b128 v[144:147], v10 offset:8192
    ds_read_b128 v[148:151], v11 offset:8192
    ds_read_b128 v[152:155], v12 offset:8192
    ds_read_b128 v[156:159], v13 offset:8192
    s_waitcnt lgkmcnt(7)
    v_mfma_f32_32x32x16_bf16 v[80:95], v[128:131], v[32:35], 0
    s_waitcnt lgkmcnt(6)
    v_mfma_f32_32x32x16_bf16 v[80:95], v[132:135], v[36:39], v[80:95]
    s_waitcnt lgkmcnt(5)
    v_mfma_f32_32x32x16_bf16 v[80:95], v[136:139], v[40:43], v[80:95]
    s_waitcnt lgkmcnt(4)
    v_mfma_f32_32x32x16_bf16 v[80:95], v[140:143], v[44:47], v[80:95]
    s_waitcnt lgkmcnt(3)
    v_mfma_f32_32x32x16_bf16 v[80:95], v[144:147], v[48:51], v[80:95]
    s_waitcnt lgkmcnt(2)
    v_mfma_f32_32x32x16_bf16 v[80:95], v[148:151], v[52:55], v[80:95]
    s_waitcnt lgkmcnt(1)
    v_mfma_f32_32x32x16_bf16 v[80:95], v[152:155], v[56:59], v[80:95]
    s_waitcnt lgkmcnt(0)
    v_mfma_f32_32x32x16_bf16 v[80:95], v[156:159], v[60:63], v[80:95]
    s_cmp_lg_u32 s59, 0
    s_cbranch_scc1 L_nonld
    global_load_dwordx2 v[228:229], v221, s[16:17] sc1
L_nonld:
    s_nop 3
    v_cmp_lt_i32 s[80:81], 0, v24
    v_cmp_lt_i32 s[82:83], 1, v24
    v_cmp_lt_i32 s[84:85], 2, v24
    v_cmp_lt_i32 s[86:87], 3, v24
    v_cmp_lt_i32 s[88:89], 8, v24
    v_cmp_lt_i32 s[90:91], 9, v24
    v_cmp_lt_i32 s[92:93], 10, v24
    v_cmp_lt_i32 s[94:95], 11, v24
    v_cndmask_b32 v80, v31, v80, s[80:81]
    v_cndmask_b32 v81, v31, v81, s[82:83]
    v_cndmask_b32 v82, v31, v82, s[84:85]
    v_cndmask_b32 v83, v31, v83, s[86:87]
    v_cndmask_b32 v84, v31, v84, s[88:89]
    v_cndmask_b32 v85, v31, v85, s[90:91]
    v_cndmask_b32 v86, v31, v86, s[92:93]
    v_cndmask_b32 v87, v31, v87, s[94:95]
    v_max3_f32 v30, v30, v80, v81
    v_max3_f32 v30, v30, v82, v83
    v_max3_f32 v30, v30, v84, v85
    v_max3_f32 v30, v30, v86, v87
    v_cmp_lt_i32 s[80:81], 0, v25
    v_cmp_lt_i32 s[82:83], 1, v25
    v_cmp_lt_i32 s[84:85], 2, v25
    v_cmp_lt_i32 s[86:87], 3, v25
    v_cmp_lt_i32 s[88:89], 8, v25
    v_cmp_lt_i32 s[90:91], 9, v25
    v_cmp_lt_i32 s[92:93], 10, v25
    v_cmp_lt_i32 s[94:95], 11, v25
    v_cndmask_b32 v88, v31, v88, s[80:81]
    v_cndmask_b32 v89, v31, v89, s[82:83]
    v_cndmask_b32 v90, v31, v90, s[84:85]
    v_cndmask_b32 v91, v31, v91, s[86:87]
    v_cndmask_b32 v92, v31, v92, s[88:89]
    v_cndmask_b32 v93, v31, v93, s[90:91]
    v_cndmask_b32 v94, v31, v94, s[92:93]
    v_cndmask_b32 v95, v31, v95, s[94:95]
    v_max3_f32 v30, v30, v88, v89
    v_max3_f32 v30, v30, v90, v91
    v_max3_f32 v30, v30, v92, v93
    v_max3_f32 v30, v30, v94, v95
    s_barrier
    ds_read_b128 v[128:131], v6 offset:16384
    ds_read_b128 v[132:135], v7 offset:16384
    ds_read_b128 v[136:139], v8 offset:16384
    ds_read_b128 v[140:143], v9 offset:16384
    ds_read_b128 v[144:147], v10 offset:16384
    ds_read_b128 v[148:151], v11 offset:16384
    ds_read_b128 v[152:155], v12 offset:16384
    ds_read_b128 v[156:159], v13 offset:16384
    s_waitcnt lgkmcnt(7)
    v_mfma_f32_32x32x16_bf16 v[96:111], v[128:131], v[32:35], 0
    s_waitcnt lgkmcnt(6)
    v_mfma_f32_32x32x16_bf16 v[96:111], v[132:135], v[36:39], v[96:111]
    s_waitcnt lgkmcnt(5)
    v_mfma_f32_32x32x16_bf16 v[96:111], v[136:139], v[40:43], v[96:111]
    s_waitcnt lgkmcnt(4)
    v_mfma_f32_32x32x16_bf16 v[96:111], v[140:143], v[44:47], v[96:111]
    s_waitcnt lgkmcnt(3)
    v_mfma_f32_32x32x16_bf16 v[96:111], v[144:147], v[48:51], v[96:111]
    s_waitcnt lgkmcnt(2)
    v_mfma_f32_32x32x16_bf16 v[96:111], v[148:151], v[52:55], v[96:111]
    s_waitcnt lgkmcnt(1)
    v_mfma_f32_32x32x16_bf16 v[96:111], v[152:155], v[56:59], v[96:111]
    s_waitcnt lgkmcnt(0)
    v_mfma_f32_32x32x16_bf16 v[96:111], v[156:159], v[60:63], v[96:111]
    s_nop 3
    v_cmp_lt_i32 s[80:81], 0, v26
    v_cmp_lt_i32 s[82:83], 1, v26
    v_cmp_lt_i32 s[84:85], 2, v26
    v_cmp_lt_i32 s[86:87], 3, v26
    v_cmp_lt_i32 s[88:89], 8, v26
    v_cmp_lt_i32 s[90:91], 9, v26
    v_cmp_lt_i32 s[92:93], 10, v26
    v_cmp_lt_i32 s[94:95], 11, v26
    v_cndmask_b32 v96, v31, v96, s[80:81]
    v_cndmask_b32 v97, v31, v97, s[82:83]
    v_cndmask_b32 v98, v31, v98, s[84:85]
    v_cndmask_b32 v99, v31, v99, s[86:87]
    v_cndmask_b32 v100, v31, v100, s[88:89]
    v_cndmask_b32 v101, v31, v101, s[90:91]
    v_cndmask_b32 v102, v31, v102, s[92:93]
    v_cndmask_b32 v103, v31, v103, s[94:95]
    v_max3_f32 v30, v30, v96, v97
    v_max3_f32 v30, v30, v98, v99
    v_max3_f32 v30, v30, v100, v101
    v_max3_f32 v30, v30, v102, v103
    v_cmp_lt_i32 s[80:81], 0, v27
    v_cmp_lt_i32 s[82:83], 1, v27
    v_cmp_lt_i32 s[84:85], 2, v27
    v_cmp_lt_i32 s[86:87], 3, v27
    v_cmp_lt_i32 s[88:89], 8, v27
    v_cmp_lt_i32 s[90:91], 9, v27
    v_cmp_lt_i32 s[92:93], 10, v27
    v_cmp_lt_i32 s[94:95], 11, v27
    v_cndmask_b32 v104, v31, v104, s[80:81]
    v_cndmask_b32 v105, v31, v105, s[82:83]
    v_cndmask_b32 v106, v31, v106, s[84:85]
    v_cndmask_b32 v107, v31, v107, s[86:87]
    v_cndmask_b32 v108, v31, v108, s[88:89]
    v_cndmask_b32 v109, v31, v109, s[90:91]
    v_cndmask_b32 v110, v31, v110, s[92:93]
    v_cndmask_b32 v111, v31, v111, s[94:95]
    v_max3_f32 v30, v30, v104, v105
    v_max3_f32 v30, v30, v106, v107
    v_max3_f32 v30, v30, v108, v109
    v_max3_f32 v30, v30, v110, v111
    s_barrier
    ds_read_b128 v[128:131], v6 offset:24576
    ds_read_b128 v[132:135], v7 offset:24576
    ds_read_b128 v[136:139], v8 offset:24576
    ds_read_b128 v[140:143], v9 offset:24576
    ds_read_b128 v[144:147], v10 offset:24576
    ds_read_b128 v[148:151], v11 offset:24576
    ds_read_b128 v[152:155], v12 offset:24576
    ds_read_b128 v[156:159], v13 offset:24576
    s_waitcnt lgkmcnt(7)
    v_mfma_f32_32x32x16_bf16 v[112:127], v[128:131], v[32:35], 0
    s_waitcnt lgkmcnt(6)
    v_mfma_f32_32x32x16_bf16 v[112:127], v[132:135], v[36:39], v[112:127]
    s_waitcnt lgkmcnt(5)
    v_mfma_f32_32x32x16_bf16 v[112:127], v[136:139], v[40:43], v[112:127]
    s_waitcnt lgkmcnt(4)
    v_mfma_f32_32x32x16_bf16 v[112:127], v[140:143], v[44:47], v[112:127]
    s_waitcnt lgkmcnt(3)
    v_mfma_f32_32x32x16_bf16 v[112:127], v[144:147], v[48:51], v[112:127]
    s_waitcnt lgkmcnt(2)
    v_mfma_f32_32x32x16_bf16 v[112:127], v[148:151], v[52:55], v[112:127]
    s_waitcnt lgkmcnt(1)
    v_mfma_f32_32x32x16_bf16 v[112:127], v[152:155], v[56:59], v[112:127]
    s_waitcnt lgkmcnt(0)
    v_mfma_f32_32x32x16_bf16 v[112:127], v[156:159], v[60:63], v[112:127]
    s_nop 3
    v_cmp_lt_i32 s[80:81], 0, v28
    v_cmp_lt_i32 s[82:83], 1, v28
    v_cmp_lt_i32 s[84:85], 2, v28
    v_cmp_lt_i32 s[86:87], 3, v28
    v_cmp_lt_i32 s[88:89], 8, v28
    v_cmp_lt_i32 s[90:91], 9, v28
    v_cmp_lt_i32 s[92:93], 10, v28
    v_cmp_lt_i32 s[94:95], 11, v28
    v_cndmask_b32 v112, v31, v112, s[80:81]
    v_cndmask_b32 v113, v31, v113, s[82:83]
    v_cndmask_b32 v114, v31, v114, s[84:85]
    v_cndmask_b32 v115, v31, v115, s[86:87]
    v_cndmask_b32 v116, v31, v116, s[88:89]
    v_cndmask_b32 v117, v31, v117, s[90:91]
    v_cndmask_b32 v118, v31, v118, s[92:93]
    v_cndmask_b32 v119, v31, v119, s[94:95]
    v_max3_f32 v30, v30, v112, v113
    v_max3_f32 v30, v30, v114, v115
    v_max3_f32 v30, v30, v116, v117
    v_max3_f32 v30, v30, v118, v119
    v_cmp_lt_i32 s[80:81], 0, v29
    v_cmp_lt_i32 s[82:83], 1, v29
    v_cmp_lt_i32 s[84:85], 2, v29
    v_cmp_lt_i32 s[86:87], 3, v29
    v_cmp_lt_i32 s[88:89], 8, v29
    v_cmp_lt_i32 s[90:91], 9, v29
    v_cmp_lt_i32 s[92:93], 10, v29
    v_cmp_lt_i32 s[94:95], 11, v29
    v_cndmask_b32 v120, v31, v120, s[80:81]
    v_cndmask_b32 v121, v31, v121, s[82:83]
    v_cndmask_b32 v122, v31, v122, s[84:85]
    v_cndmask_b32 v123, v31, v123, s[86:87]
    v_cndmask_b32 v124, v31, v124, s[88:89]
    v_cndmask_b32 v125, v31, v125, s[90:91]
    v_cndmask_b32 v126, v31, v126, s[92:93]
    v_cndmask_b32 v127, v31, v127, s[94:95]
    v_max3_f32 v30, v30, v120, v121
    v_max3_f32 v30, v30, v122, v123
    v_max3_f32 v30, v30, v124, v125
    v_max3_f32 v30, v30, v126, v127
    s_cmp_lg_u32 s59, 0
    s_cbranch_scc1 L_nonw0
    s_waitcnt vmcnt(0)
    s_mov_b32 s99, 0
L_noncewaitC:
    v_readfirstlane_b32 s6, v228
    v_readfirstlane_b32 s7, v229
    s_nop 1
    s_cmp_lg_u32 s6, 0
    s_cbranch_scc1 L_nonceokC
    s_add_u32 s99, s99, 1
    s_cmp_gt_u32 s99, 0x100000
    s_cbranch_scc1 L_nonceokC
    s_sleep 2
    global_load_dwordx2 v[228:229], v221, s[16:17] sc1
    s_waitcnt vmcnt(0)
    s_branch L_noncewaitC
L_nonceokC:
L_nonw0:
    v_mov_b32 v192, v30
    s_nop 1
    v_permlane32_swap_b32 v30, v192
    v_mov_b32 v193, s8
    v_cmp_gt_u32 vcc, 32, v1
    v_max_f32 v30, v30, v192
    v_lshlrev_b32 v194, 2, v1
    v_cndmask_b32 v195, v193, v30, vcc
    v_writelane_b32 v195, s6, 62
    v_writelane_b32 v195, s7, 63
    v_writelane_b32 v193, s6, 2
    v_writelane_b32 v193, s7, 3
    s_lshl_b32 s96, s59, 8
    s_add_u32 s96, s96, 0x20000
    v_add_u32 v194, s96, v194
    ds_write_b32 v194, v195 offset:0
    ds_write_b32 v194, v195 offset:8192
    ds_write_b32 v194, v195 offset:16384
    ds_write_b32 v194, v195 offset:24576
    s_add_u32 s96, s100, 24576
    v_lshlrev_b32 v194, 2, v1
    v_add_u32 v194, s96, v194
    ds_write_b32 v194, v193
    v_and_b32 v195, 31, v1
    v_lshlrev_b32 v195, 2, v195
    s_lshl_b32 s96, s59, 13
    s_add_u32 s96, s96, 0x20000
    v_add_u32 v195, s96, v195
    s_waitcnt lgkmcnt(0)
    s_barrier
    ds_read2_b32 v[128:129], v195 offset0:0 offset1:32
    ds_read2_b32 v[130:131], v195 offset0:64 offset1:96
    ds_read2_b32 v[132:133], v195 offset0:128 offset1:160
    ds_read2_b32 v[134:135], v195 offset0:192 offset1:224
    v_mov_b32 v196, s96
    ds_read_b64 v[136:137], v196 offset:248
    s_waitcnt lgkmcnt(0)
    v_readfirstlane_b32 s6, v136
    v_readfirstlane_b32 s7, v137
    v_or3_b32 v192, v129, v131, v133
    v_or_b32 v192, v192, v135
    v_max3_f32 v30, v128, v130, v132
    v_readfirstlane_b32 s96, v192
    v_mov_b32 v192, 0xf149f2ca
    v_max3_f32 v30, v30, v134, v192
    s_nop 1
    s_cmp_lg_u32 s96, 0
    s_cbranch_scc1 C_fallback
    s_mov_b32 s96, 0x3e0293ee
    v_mul_f32 v219, 0xbe0293ee, v30
    v_fma_f32 v64, v64, s96, v219
    v_fma_f32 v65, v65, s96, v219
    v_fma_f32 v66, v66, s96, v219
    v_fma_f32 v67, v67, s96, v219
    v_fma_f32 v68, v68, s96, v219
    v_fma_f32 v69, v69, s96, v219
    v_fma_f32 v70, v70, s96, v219
    v_fma_f32 v71, v71, s96, v219
    v_exp_f32 v64, v64
    v_exp_f32 v65, v65
    v_exp_f32 v66, v66
    v_exp_f32 v67, v67
    v_exp_f32 v68, v68
    v_exp_f32 v69, v69
    v_exp_f32 v70, v70
    v_exp_f32 v71, v71
    v_cvt_pk_bf16_f32 v192, v64, v65
    v_cvt_pk_bf16_f32 v193, v66, v67
    v_cvt_pk_bf16_f32 v194, v68, v69
    v_cvt_pk_bf16_f32 v195, v70, v71
    ds_write_b128 v18, v[192:195] offset:0
    s_nop 0
    v_mfma_f32_32x32x16_bf16 v[240:255], v[208:211], v[192:195], 0
    v_fma_f32 v72, v72, s96, v219
    v_fma_f32 v73, v73, s96, v219
    v_fma_f32 v74, v74, s96, v219
    v_fma_f32 v75, v75, s96, v219
    v_fma_f32 v76, v76, s96, v219
    v_fma_f32 v77, v77, s96, v219
    v_fma_f32 v78, v78, s96, v219
    v_fma_f32 v79, v79, s96, v219
    v_exp_f32 v72, v72
    v_exp_f32 v73, v73
    v_exp_f32 v74, v74
    v_exp_f32 v75, v75
    v_exp_f32 v76, v76
    v_exp_f32 v77, v77
    v_exp_f32 v78, v78
    v_exp_f32 v79, v79
    v_cvt_pk_bf16_f32 v196, v72, v73
    v_cvt_pk_bf16_f32 v197, v74, v75
    v_cvt_pk_bf16_f32 v198, v76, v77
    v_cvt_pk_bf16_f32 v199, v78, v79
    ds_write_b128 v18, v[196:199] offset:1024
    s_nop 0
    v_mfma_f32_32x32x16_bf16 v[240:255], v[208:211], v[196:199], v[240:255]
    v_fma_f32 v80, v80, s96, v219
    v_fma_f32 v81, v81, s96, v219
    v_fma_f32 v82, v82, s96, v219
    v_fma_f32 v83, v83, s96, v219
    v_fma_f32 v84, v84, s96, v219
    v_fma_f32 v85, v85, s96, v219
    v_fma_f32 v86, v86, s96, v219
    v_fma_f32 v87, v87, s96, v219
    v_exp_f32 v80, v80
    v_exp_f32 v81, v81
    v_exp_f32 v82, v82
    v_exp_f32 v83, v83
    v_exp_f32 v84, v84
    v_exp_f32 v85, v85
    v_exp_f32 v86, v86
    v_exp_f32 v87, v87
    v_cvt_pk_bf16_f32 v192, v80, v81
    v_cvt_pk_bf16_f32 v193, v82, v83
    v_cvt_pk_bf16_f32 v194, v84, v85
    v_cvt_pk_bf16_f32 v195, v86, v87
    ds_write_b128 v18, v[192:195] offset:2048
    s_nop 0
    v_mfma_f32_32x32x16_bf16 v[240:255], v[208:211], v[192:195], v[240:255]
    v_fma_f32 v88, v88, s96, v219
    v_fma_f32 v89, v89, s96, v219
    v_fma_f32 v90, v90, s96, v219
    v_fma_f32 v91, v91, s96, v219
    v_fma_f32 v92, v92, s96, v219
    v_fma_f32 v93, v93, s96, v219
    v_fma_f32 v94, v94, s96, v219
    v_fma_f32 v95, v95, s96, v219
    v_exp_f32 v88, v88
    v_exp_f32 v89, v89
    v_exp_f32 v90, v90
    v_exp_f32 v91, v91
    v_exp_f32 v92, v92
    v_exp_f32 v93, v93
    v_exp_f32 v94, v94
    v_exp_f32 v95, v95
    v_cvt_pk_bf16_f32 v196, v88, v89
    v_cvt_pk_bf16_f32 v197, v90, v91
    v_cvt_pk_bf16_f32 v198, v92, v93
    v_cvt_pk_bf16_f32 v199, v94, v95
    ds_write_b128 v18, v[196:199] offset:3072
    s_nop 0
    v_mfma_f32_32x32x16_bf16 v[240:255], v[208:211], v[196:199], v[240:255]
    v_fma_f32 v96, v96, s96, v219
    v_fma_f32 v97, v97, s96, v219
    v_fma_f32 v98, v98, s96, v219
    v_fma_f32 v99, v99, s96, v219
    v_fma_f32 v100, v100, s96, v219
    v_fma_f32 v101, v101, s96, v219
    v_fma_f32 v102, v102, s96, v219
    v_fma_f32 v103, v103, s96, v219
    v_exp_f32 v96, v96
    v_exp_f32 v97, v97
    v_exp_f32 v98, v98
    v_exp_f32 v99, v99
    v_exp_f32 v100, v100
    v_exp_f32 v101, v101
    v_exp_f32 v102, v102
    v_exp_f32 v103, v103
    v_cvt_pk_bf16_f32 v192, v96, v97
    v_cvt_pk_bf16_f32 v193, v98, v99
    v_cvt_pk_bf16_f32 v194, v100, v101
    v_cvt_pk_bf16_f32 v195, v102, v103
    ds_write_b128 v18, v[192:195] offset:4096
    s_nop 0
    v_mfma_f32_32x32x16_bf16 v[240:255], v[208:211], v[192:195], v[240:255]
    v_fma_f32 v104, v104, s96, v219
    v_fma_f32 v105, v105, s96, v219
    v_fma_f32 v106, v106, s96, v219
    v_fma_f32 v107, v107, s96, v219
    v_fma_f32 v108, v108, s96, v219
    v_fma_f32 v109, v109, s96, v219
    v_fma_f32 v110, v110, s96, v219
    v_fma_f32 v111, v111, s96, v219
    v_exp_f32 v104, v104
    v_exp_f32 v105, v105
    v_exp_f32 v106, v106
    v_exp_f32 v107, v107
    v_exp_f32 v108, v108
    v_exp_f32 v109, v109
    v_exp_f32 v110, v110
    v_exp_f32 v111, v111
    v_cvt_pk_bf16_f32 v196, v104, v105
    v_cvt_pk_bf16_f32 v197, v106, v107
    v_cvt_pk_bf16_f32 v198, v108, v109
    v_cvt_pk_bf16_f32 v199, v110, v111
    ds_write_b128 v18, v[196:199] offset:5120
    s_nop 0
    v_mfma_f32_32x32x16_bf16 v[240:255], v[208:211], v[196:199], v[240:255]
    v_fma_f32 v112, v112, s96, v219
    v_fma_f32 v113, v113, s96, v219
    v_fma_f32 v114, v114, s96, v219
    v_fma_f32 v115, v115, s96, v219
    v_fma_f32 v116, v116, s96, v219
    v_fma_f32 v117, v117, s96, v219
    v_fma_f32 v118, v118, s96, v219
    v_fma_f32 v119, v119, s96, v219
    v_exp_f32 v112, v112
    v_exp_f32 v113, v113
    v_exp_f32 v114, v114
    v_exp_f32 v115, v115
    v_exp_f32 v116, v116
    v_exp_f32 v117, v117
    v_exp_f32 v118, v118
    v_exp_f32 v119, v119
    v_cvt_pk_bf16_f32 v192, v112, v113
    v_cvt_pk_bf16_f32 v193, v114, v115
    v_cvt_pk_bf16_f32 v194, v116, v117
    v_cvt_pk_bf16_f32 v195, v118, v119
    ds_write_b128 v18, v[192:195] offset:6144
    s_nop 0
    v_mfma_f32_32x32x16_bf16 v[240:255], v[208:211], v[192:195], v[240:255]
    v_fma_f32 v120, v120, s96, v219
    v_fma_f32 v121, v121, s96, v219
    v_fma_f32 v122, v122, s96, v219
    v_fma_f32 v123, v123, s96, v219
    v_fma_f32 v124, v124, s96, v219
    v_fma_f32 v125, v125, s96, v219
    v_fma_f32 v126, v126, s96, v219
    v_fma_f32 v127, v127, s96, v219
    v_exp_f32 v120, v120
    v_exp_f32 v121, v121
    v_exp_f32 v122, v122
    v_exp_f32 v123, v123
    v_exp_f32 v124, v124
    v_exp_f32 v125, v125
    v_exp_f32 v126, v126
    v_exp_f32 v127, v127
    v_cvt_pk_bf16_f32 v196, v120, v121
    v_cvt_pk_bf16_f32 v197, v122, v123
    v_cvt_pk_bf16_f32 v198, v124, v125
    v_cvt_pk_bf16_f32 v199, v126, v127
    ds_write_b128 v18, v[196:199] offset:7168
    s_nop 0
    v_mfma_f32_32x32x16_bf16 v[240:255], v[208:211], v[196:199], v[240:255]
    s_waitcnt vmcnt(0)
    v_mov_b32 v202, s6
    v_mov_b32 v203, s7
    v_bfe_u32 v196, v1, 2, 3
    v_lshrrev_b32_e64 v197, v196, s66
    v_and_b32 v197, 1, v197
    v_cmp_eq_u32 vcc, 1, v197
    v_lshlrev_b32 v196, 8, v196
    v_and_b32 v197, 3, v1
    v_lshl_add_u32 v196, v197, 4, v196
    v_mov_b32 v200, v30
    s_nop 3
    v_mov_b32 v201, v240
    s_and_b32 exec_lo, vcc_lo, -1
    s_mov_b32 exec_hi, 0
    s_cbranch_execz L_noml2
    buffer_store_dwordx4 v[200:203], v196, s[28:31], s68 offen sc1
L_noml2:
    s_mov_b64 exec, -1
    s_waitcnt lgkmcnt(0)
    s_barrier
    s_mov_b32 s72, 0x07060503
    s_mov_b32 s73, 0x07060502
    s_mov_b32 s74, 0x07060501
    v_mov_b32 v207, s6
    v_mov_b32 v195, s6
    ds_read_b128 v[64:67], v19 offset:0
    ds_read_b64_tr_b16 v[128:129], v14 offset:0
    ds_read_b64_tr_b16 v[130:131], v15 offset:0
    ds_read_b128 v[68:71], v19 offset:1024
    ds_read_b64_tr_b16 v[132:133], v14 offset:4096
    ds_read_b64_tr_b16 v[134:135], v15 offset:4096
    ds_read_b128 v[72:75], v19 offset:8192
    ds_read_b64_tr_b16 v[136:137], v14 offset:32768
    ds_read_b64_tr_b16 v[138:139], v15 offset:32768
    ds_read_b128 v[76:79], v19 offset:9216
    ds_read_b64_tr_b16 v[140:141], v14 offset:36864
    ds_read_b64_tr_b16 v[142:143], v15 offset:36864
    s_waitcnt lgkmcnt(9)
    v_mfma_f32_32x32x16_bf16 v[224:239], v[64:67], v[128:131], 0
    ds_read_b128 v[80:83], v19 offset:16384
    ds_read_b64_tr_b16 v[144:145], v16 offset:0
    ds_read_b64_tr_b16 v[146:147], v17 offset:0
    s_waitcnt lgkmcnt(9)
    v_mfma_f32_32x32x16_bf16 v[224:239], v[68:71], v[132:135], v[224:239]
    ds_read_b128 v[84:87], v19 offset:17408
    ds_read_b64_tr_b16 v[148:149], v16 offset:4096
    ds_read_b64_tr_b16 v[150:151], v17 offset:4096
    s_waitcnt lgkmcnt(9)
    v_mfma_f32_32x32x16_bf16 v[224:239], v[72:75], v[136:139], v[224:239]
    ds_read_b128 v[88:91], v19 offset:24576
    ds_read_b64_tr_b16 v[152:153], v16 offset:32768
    ds_read_b64_tr_b16 v[154:155], v17 offset:32768
    s_waitcnt lgkmcnt(9)
    v_mfma_f32_32x32x16_bf16 v[224:239], v[76:79], v[140:143], v[224:239]
    ds_read_b128 v[92:95], v19 offset:25600
    ds_read_b64_tr_b16 v[156:157], v16 offset:36864
    ds_read_b64_tr_b16 v[158:159], v17 offset:36864
    s_waitcnt lgkmcnt(9)
    v_mfma_f32_32x32x16_bf16 v[224:239], v[80:83], v[144:147], v[224:239]
    ds_read_b128 v[96:99], v19 offset:2048
    ds_read_b64_tr_b16 v[160:161], v14 offset:8192
    ds_read_b64_tr_b16 v[162:163], v15 offset:8192
    s_waitcnt lgkmcnt(9)
    v_mfma_f32_32x32x16_bf16 v[224:239], v[84:87], v[148:151], v[224:239]
    ds_read_b128 v[100:103], v19 offset:3072
    ds_read_b64_tr_b16 v[164:165], v14 offset:12288
    ds_read_b64_tr_b16 v[166:167], v15 offset:12288
    s_waitcnt lgkmcnt(9)
    v_mfma_f32_32x32x16_bf16 v[224:239], v[88:91], v[152:155], v[224:239]
    ds_read_b128 v[104:107], v19 offset:10240
    ds_read_b64_tr_b16 v[168:169], v14 offset:40960
    ds_read_b64_tr_b16 v[170:171], v15 offset:40960
    s_waitcnt lgkmcnt(9)
    v_mfma_f32_32x32x16_bf16 v[224:239], v[92:95], v[156:159], v[224:239]
    ds_read_b128 v[108:111], v19 offset:11264
    ds_read_b64_tr_b16 v[172:173], v14 offset:45056
    ds_read_b64_tr_b16 v[174:175], v15 offset:45056
    s_waitcnt lgkmcnt(9)
    v_mfma_f32_32x32x16_bf16 v[224:239], v[96:99], v[160:163], v[224:239]
    ds_read_b128 v[112:115], v19 offset:18432
    ds_read_b64_tr_b16 v[176:177], v16 offset:8192
    ds_read_b64_tr_b16 v[178:179], v17 offset:8192
    s_waitcnt lgkmcnt(9)
    v_mfma_f32_32x32x16_bf16 v[224:239], v[100:103], v[164:167], v[224:239]
    ds_read_b128 v[116:119], v19 offset:19456
    ds_read_b64_tr_b16 v[180:181], v16 offset:12288
    ds_read_b64_tr_b16 v[182:183], v17 offset:12288
    s_waitcnt lgkmcnt(9)
    v_mfma_f32_32x32x16_bf16 v[224:239], v[104:107], v[168:171], v[224:239]
    ds_read_b128 v[120:123], v19 offset:26624
    ds_read_b64_tr_b16 v[184:185], v16 offset:40960
    ds_read_b64_tr_b16 v[186:187], v17 offset:40960
    s_waitcnt lgkmcnt(9)
    v_mfma_f32_32x32x16_bf16 v[224:239], v[108:111], v[172:175], v[224:239]
    ds_read_b128 v[124:127], v19 offset:27648
    ds_read_b64_tr_b16 v[188:189], v16 offset:45056
    ds_read_b64_tr_b16 v[190:191], v17 offset:45056
    s_waitcnt lgkmcnt(9)
    v_mfma_f32_32x32x16_bf16 v[224:239], v[112:115], v[176:179], v[224:239]
    s_waitcnt lgkmcnt(6)
    v_mfma_f32_32x32x16_bf16 v[224:239], v[116:119], v[180:183], v[224:239]
    s_waitcnt lgkmcnt(3)
    v_mfma_f32_32x32x16_bf16 v[224:239], v[120:123], v[184:187], v[224:239]
    s_waitcnt lgkmcnt(0)
    v_mfma_f32_32x32x16_bf16 v[224:239], v[124:127], v[188:191], v[224:239]
    ds_read_b128 v[64:67], v19 offset:4096
    ds_read_b128 v[68:71], v19 offset:5120
    ds_read_b128 v[72:75], v19 offset:12288
    ds_read_b128 v[76:79], v19 offset:13312
    ds_read_b128 v[80:83], v19 offset:20480
    ds_read_b128 v[84:87], v19 offset:21504
    ds_read_b128 v[88:91], v19 offset:28672
    ds_read_b128 v[92:95], v19 offset:29696
    ds_read_b128 v[96:99], v19 offset:6144
    ds_read_b128 v[100:103], v19 offset:7168
    ds_read_b128 v[104:107], v19 offset:14336
    ds_read_b128 v[108:111], v19 offset:15360
    ds_read_b128 v[112:115], v19 offset:22528
    ds_read_b128 v[116:119], v19 offset:23552
    ds_read_b128 v[120:123], v19 offset:30720
    ds_read_b128 v[124:127], v19 offset:31744
    s_mul_i32 s99, s62, 896
    s_waitcnt lgkmcnt(0)
    s_barrier
    ds_read_b64_tr_b16 v[128:129], v14 offset:16384
    ds_read_b64_tr_b16 v[130:131], v15 offset:16384
    ds_read_b64_tr_b16 v[132:133], v14 offset:20480
    ds_read_b64_tr_b16 v[134:135], v15 offset:20480
    ds_read_b64_tr_b16 v[136:137], v14 offset:49152
    ds_read_b64_tr_b16 v[138:139], v15 offset:49152
    ds_read_b64_tr_b16 v[140:141], v14 offset:53248
    ds_read_b64_tr_b16 v[142:143], v15 offset:53248
    ds_read_b64_tr_b16 v[144:145], v16 offset:16384
    ds_read_b64_tr_b16 v[146:147], v17 offset:16384
    ds_read_b64_tr_b16 v[148:149], v16 offset:20480
    ds_read_b64_tr_b16 v[150:151], v17 offset:20480
    ds_read_b64_tr_b16 v[152:153], v16 offset:49152
    ds_read_b64_tr_b16 v[154:155], v17 offset:49152
    ds_read_b64_tr_b16 v[156:157], v16 offset:53248
    ds_read_b64_tr_b16 v[158:159], v17 offset:53248
    s_waitcnt lgkmcnt(14)
    v_mfma_f32_32x32x16_bf16 v[224:239], v[64:67], v[128:131], v[224:239]
    s_waitcnt lgkmcnt(12)
    v_mfma_f32_32x32x16_bf16 v[224:239], v[68:71], v[132:135], v[224:239]
    s_waitcnt lgkmcnt(10)
    v_mfma_f32_32x32x16_bf16 v[224:239], v[72:75], v[136:139], v[224:239]
    s_waitcnt lgkmcnt(8)
    v_mfma_f32_32x32x16_bf16 v[224:239], v[76:79], v[140:143], v[224:239]
    s_waitcnt lgkmcnt(6)
    v_mfma_f32_32x32x16_bf16 v[224:239], v[80:83], v[144:147], v[224:239]
    s_waitcnt lgkmcnt(4)
    v_mfma_f32_32x32x16_bf16 v[224:239], v[84:87], v[148:151], v[224:239]
    s_waitcnt lgkmcnt(2)
    v_mfma_f32_32x32x16_bf16 v[224:239], v[88:91], v[152:155], v[224:239]
    s_waitcnt lgkmcnt(0)
    v_mfma_f32_32x32x16_bf16 v[224:239], v[92:95], v[156:159], v[224:239]
    s_barrier
    ds_read_b64_tr_b16 v[160:161], v14 offset:24576
    ds_read_b64_tr_b16 v[162:163], v15 offset:24576
    ds_read_b64_tr_b16 v[168:169], v14 offset:57344
    ds_read_b64_tr_b16 v[170:171], v15 offset:57344
    ds_read_b64_tr_b16 v[176:177], v16 offset:24576
    ds_read_b64_tr_b16 v[178:179], v17 offset:24576
    ds_read_b64_tr_b16 v[184:185], v16 offset:57344
    ds_read_b64_tr_b16 v[186:187], v17 offset:57344
    s_waitcnt lgkmcnt(6)
    v_mfma_f32_32x32x16_bf16 v[224:239], v[96:99], v[160:163], v[224:239]
    s_waitcnt lgkmcnt(4)
    v_mfma_f32_32x32x16_bf16 v[224:239], v[104:107], v[168:171], v[224:239]
    s_waitcnt lgkmcnt(2)
    v_mfma_f32_32x32x16_bf16 v[224:239], v[112:115], v[176:179], v[224:239]
    s_waitcnt lgkmcnt(0)
    v_mfma_f32_32x32x16_bf16 v[224:239], v[120:123], v[184:187], v[224:239]
    s_cmp_le_u32 s48, s99
    s_cbranch_scc1 L_pv3done
    ds_read_b64_tr_b16 v[164:165], v14 offset:28672
    ds_read_b64_tr_b16 v[166:167], v15 offset:28672
    ds_read_b64_tr_b16 v[172:173], v14 offset:61440
    ds_read_b64_tr_b16 v[174:175], v15 offset:61440
    ds_read_b64_tr_b16 v[180:181], v16 offset:28672
    ds_read_b64_tr_b16 v[182:183], v17 offset:28672
    ds_read_b64_tr_b16 v[188:189], v16 offset:61440
    ds_read_b64_tr_b16 v[190:191], v17 offset:61440
    s_waitcnt lgkmcnt(6)
    v_mfma_f32_32x32x16_bf16 v[224:239], v[100:103], v[164:167], v[224:239]
    s_waitcnt lgkmcnt(4)
    v_mfma_f32_32x32x16_bf16 v[224:239], v[108:111], v[172:175], v[224:239]
    s_waitcnt lgkmcnt(2)
    v_mfma_f32_32x32x16_bf16 v[224:239], v[116:119], v[180:183], v[224:239]
    s_waitcnt lgkmcnt(0)
    v_mfma_f32_32x32x16_bf16 v[224:239], v[124:127], v[188:191], v[224:239]
L_pv3done:
    s_nop 8
    s_bfe_i32 exec_lo, s66, 0x10000
    s_bfe_i32 exec_hi, s66, 0x10001
    s_add_u32 s98, s67, 0
    s_cbranch_execz L_skipo0
    v_perm_b32 v204, v224, v227, s72
    v_perm_b32 v205, v225, v227, s73
    v_perm_b32 v206, v226, v227, s74
    buffer_store_dwordx4 v[204:207], v212, s[28:31], s98 offen sc1
L_skipo0:
    s_bfe_i32 exec_lo, s66, 0x10002
    s_bfe_i32 exec_hi, s66, 0x10003
    s_add_u32 s98, s67, 4096
    s_cbranch_execz L_skipo1
    v_perm_b32 v192, v228, v231, s72
    v_perm_b32 v193, v229, v231, s73
    v_perm_b32 v194, v230, v231, s74
    buffer_store_dwordx4 v[192:195], v212, s[28:31], s98 offen sc1
L_skipo1:
    s_bfe_i32 exec_lo, s66, 0x10004
    s_bfe_i32 exec_hi, s66, 0x10005
    s_add_u32 s98, s67, 8192
    s_cbranch_execz L_skipo2
    v_perm_b32 v204, v232, v235, s72
    v_perm_b32 v205, v233, v235, s73
    v_perm_b32 v206, v234, v235, s74
    buffer_store_dwordx4 v[204:207], v212, s[28:31], s98 offen sc1
L_skipo2:
    s_bfe_i32 exec_lo, s66, 0x10006
    s_bfe_i32 exec_hi, s66, 0x10007
    s_add_u32 s98, s67, 12288
    s_cbranch_execz L_skipo3
    v_perm_b32 v192, v236, v239, s72
    v_perm_b32 v193, v237, v239, s73
    v_perm_b32 v194, v238, v239, s74
    buffer_store_dwordx4 v[192:195], v212, s[28:31], s98 offen sc1
L_skipo3:
    s_mov_b64 exec, -1
    s_add_u32 s63, s63, 1
    s_cmp_ge_u32 s63, s62
    s_cbranch_scc1 L_end
    s_waitcnt vmcnt(0)
    s_barrier
    s_branch C_round
C_fallback:
    s_waitcnt vmcnt(0) lgkmcnt(0)
    s_barrier
    s_branch C_generic
.section .rodata,"a"
.p2align 6
.amdhsa_kernel standalone__paged_block_table_kv_radixattention__sampling_kernel
  .amdhsa_next_free_vgpr 256
  .amdhsa_next_free_sgpr 102
  .amdhsa_accum_offset 256
  .amdhsa_group_segment_fixed_size 0
  .amdhsa_kernarg_size 64
  .amdhsa_user_sgpr_count 2
  .amdhsa_user_sgpr_kernarg_segment_ptr 1
  .amdhsa_system_sgpr_workgroup_id_x 1
.end_amdhsa_kernel
```
